```python
import torch

def _softmax(x, axis=-1):
    return torch.softmax(x, dim=axis)
def _gelu(x):
    return torch.nn.functional.gelu(x, approximate="tanh")
def _silu(x):
    return torch.nn.functional.silu(x)
def _sigmoid(x):
    return torch.sigmoid(x)
def _layernorm(x, axis=-1, eps=1e-5):
    m = x.mean(dim=axis, keepdim=True)
    v = x.var(dim=axis, keepdim=True, unbiased=False)
    return (x - m) / torch.sqrt(v + eps)
def _scatter_add(tgt, idx, src, axis=0):
    return tgt.clone().index_add_(axis, idx, src)
def _segment_sum(src, seg, n):
    out = torch.zeros((n,) + src.shape[1:], dtype=src.dtype)
    return out.index_add_(0, seg, src)
def _pad(x, pw):
    flat = tuple(v for pair in reversed(pw) for v in pair)
    return torch.nn.functional.pad(x, flat)

kernel_name = 'gated_mix__gqa_block_cached__dense_activation_mish__decode'

def setup_inputs():

    _w = (lambda a: (lambda t: t.to(torch.bfloat16) if t.is_floating_point() else t)(torch.as_tensor(a)))
    def _A_setup():
        B, Sq, D = 2, 1, 640
        Hq, Hkv, Sk, Dh = 32, 32, 4096, 192
        assert Hq % Hkv == 0, (Hq, Hkv)
        return {
            "x": _w((lambda *s: torch.randn(*s, dtype=torch.bfloat16) * 0.05)(B, Sq, D)),
            "k_cache": _w((lambda *s: torch.randn(*s, dtype=torch.bfloat16) * 6.4)(B, Hkv, Sk, Dh)),
            "v_cache": _w((lambda *s: torch.randn(*s, dtype=torch.bfloat16) * 0.1)(B, Hkv, Sk, Dh)),
            "wq": _w((lambda *s: torch.randn(*s, dtype=torch.bfloat16) * 6.4)(D, Hq * Dh) * (D ** -0.5)),
            "wo": _w((lambda *s: torch.randn(*s, dtype=torch.bfloat16) * 0.1)(Hq * Dh, D) * ((Hq * Dh) ** -0.5)),
        }
    _A_in = _A_setup()

    def _B_setup():
        B, S, D, F = 2, 1, 640, 1536
        return {
            "x": _w((lambda *s: torch.randn(*s, dtype=torch.bfloat16) * 0.05)(B, S, D)),
            "w1": _w((lambda *s: torch.randn(*s, dtype=torch.bfloat16) * 3.2)(D, F) * (D ** -0.5)),
            "b1": _w((lambda *s: torch.randn(*s, dtype=torch.bfloat16) * 0.05)(F)),
            "w2": _w((lambda *s: torch.randn(*s, dtype=torch.bfloat16) * 0.05)(F, D) * (F ** -0.5)),
        }
    _B_in = _B_setup()

    return {
        "A_x": _A_in["x"],
        "A_k_cache": _A_in["k_cache"],
        "A_v_cache": _A_in["v_cache"],
        "A_wq": _A_in["wq"],
        "A_wo": _A_in["wo"],
        "B_x": _B_in["x"],
        "B_w1": _B_in["w1"],
        "B_b1": _B_in["b1"],
        "B_w2": _B_in["w2"],
        "gate_w": _w((lambda *s: torch.randn(*s, dtype=torch.bfloat16) * 0.05)(640) * 16.0),
    }

def reference(A_x, A_k_cache, A_v_cache, A_wq, A_wo, B_x, B_w1, B_b1, B_w2, gate_w):
    def _A_ref(x, k_cache, v_cache, wq, wo):
        B, Sq, D = x.shape
        Hq, Dh = 32, 192
        Hkv = k_cache.shape[1]
        rep = Hq // Hkv
        q = (lambda x, *d: x.permute(*d))((x @ wq).reshape(B, Sq, Hq, Dh), 0, 2, 1, 3)
        k = (lambda x, n, axis: torch.repeat_interleave(x, n, dim=axis))(k_cache, rep, axis=1)
        v = (lambda x, n, axis: torch.repeat_interleave(x, n, dim=axis))(v_cache, rep, axis=1)
        scores = torch.einsum("bhqd,bhkd->bhqk", q, k) * (Dh ** -0.5)
        p = _softmax(scores, axis=-1)
        o = torch.einsum("bhqk,bhkd->bhqd", p, v)
        return (lambda x, *d: x.permute(*d))(o, 0, 2, 1, 3).reshape(B, Sq, Hq * Dh) @ wo

    def _B_ref(x, w1, b1, w2):
        h = torch.einsum("bsd,df->bsf", x, w1) + b1
        sp = torch.log1p(torch.exp(-torch.abs(h))) + torch.where(h > 0, h, torch.zeros_like(h))
        act = h * torch.tanh(sp)
        return torch.einsum("bsf,fd->bsd", act, w2)

    x = A_x
    g = _sigmoid((x * gate_w).sum(-1, keepdims=True))
    a = _A_ref(x, A_k_cache, A_v_cache, A_wq, A_wo)
    b = _B_ref(x, B_w1, B_b1, B_w2)
    return g * a + (1 - g) * b
```

```asm
; @launch grid=(256,1,1) block=(576,1,1) lds=34256
.amdgcn_target "amdgcn-amd-amdhsa--gfx950"
.text
.globl gated_mix__gqa_block_cached__dense_activation_mish__decode_kernel
.p2align 8
.type gated_mix__gqa_block_cached__dense_activation_mish__decode_kernel,@function
gated_mix__gqa_block_cached__dense_activation_mish__decode_kernel:
    s_cmp_ge_u32 s2, 256
    s_cbranch_scc1 L_end
    s_load_dwordx16 s[4:19], s[0:1], 0
    s_load_dwordx8 s[20:27], s[0:1], 64
    s_load_dwordx2 s[28:29], s[0:1], 96
    v_lshrrev_b32 v5, 6, v0
    v_and_b32 v1, 63, v0
    v_readfirstlane_b32 s3, v5
    s_and_b32 s82, s2, 7
    s_lshr_b32 s83, s2, 6
    s_lshl_b32 s30, s82, 2
    s_add_u32 s30, s30, s83
    s_bfe_u32 s31, s2, 196611
    v_lshrrev_b32 v6, 3, v1
    v_and_b32 v7, 7, v1
    v_lshlrev_b32 v5, 4, v7
    s_cmp_eq_u32 s3, 8
    s_cbranch_scc1 L_helper
    v_mul_u32_u24 v2, 384, v6
    v_add_u32 v2, v2, v5
    s_mul_i32 s88, s30, 2
    s_and_b32 s88, s88, 7
    s_lshl_b32 s82, s30, 6
    s_add_u32 s82, s82, s31
    s_lshl_b32 s82, s82, 3
    s_add_u32 s82, s82, s3
    s_mul_i32 s82, s82, 3072
    s_sub_u32 s34, 100663296, s82
    s_mov_b32 s35, 0x20000
    s_mul_i32 s86, s88, 196608
    s_waitcnt lgkmcnt(0)
    s_add_u32 s32, s6, s82
    s_addc_u32 s33, s7, 0
    buffer_load_dwordx4 v[36:39], v2, s[32:35], s86 offen offset:0 nt
    buffer_load_dwordx4 v[40:43], v2, s[32:35], s86 offen offset:128 nt
    buffer_load_dwordx4 v[44:47], v2, s[32:35], s86 offen offset:256 nt
    s_add_u32 s36, s8, s82
    s_addc_u32 s37, s9, 0
    s_mov_b32 s38, s34
    s_mov_b32 s39, 0x20000
    s_mov_b32 s68, s28
    s_mov_b32 s69, s29
    s_mov_b32 s70, 4194304
    s_mov_b32 s71, 0x20000
    s_lshl_b32 s99, s30, 3
    s_add_u32 s99, s99, s31
    s_lshl_b32 s99, s99, 11
    s_add_u32 s100, s99, 524288
    s_lshl_b32 s101, s31, 5
    s_add_u32 s101, s101, s30
    s_mul_i32 s101, s101, 640
    s_add_u32 s101, s101, 1572864
    s_mov_b32 s92, 262144
    s_mov_b32 s76, 1835008
    s_load_dword s79, s[28:29], s76
    s_mov_b32 s77, 4294966272
    s_mov_b32 s91, 1069066811
    s_mul_i32 s82, s30, 192
    s_mul_i32 s83, s3, 24
    s_add_u32 s82, s82, s83
    s_mul_i32 s82, s82, 1280
    s_mul_i32 s83, s31, 160
    s_add_u32 s82, s82, s83
    s_add_u32 s48, s12, s82
    s_addc_u32 s49, s13, 0
    s_sub_u32 s50, 7864320, s82
    s_mov_b32 s51, 0x20000
    s_lshl_b32 s82, s30, 3
    s_add_u32 s82, s82, s3
    s_mul_i32 s82, s82, 7680
    s_add_u32 s82, s82, s83
    s_add_u32 s52, s20, s82
    s_addc_u32 s53, s21, 0
    s_sub_u32 s54, 1966080, s82
    s_mov_b32 s55, 0x20000
    s_lshl_b32 s93, s30, 14
    s_add_u32 s93, s93, 524288
    s_add_u32 s94, s93, 4096
    s_add_u32 s95, s93, 8192
    s_add_u32 s98, s93, 12288
    v_lshrrev_b32 v8, 4, v1
    v_and_b32 v9, 15, v1
    v_mov_b32 v10, 2147483648
    v_mul_u32_u24 v3, 1280, v8
    v_lshl_add_u32 v3, v9, 4, v3
    v_mul_u32_u24 v4, 2560, v8
    v_lshl_add_u32 v4, v9, 4, v4
    v_cmp_gt_u32 vcc, 3, v8
    s_nop 1
    v_cndmask_b32 v4, v10, v4, vcc
    v_cmp_gt_u32 vcc, 10, v9
    s_nop 1
    v_cndmask_b32 v3, v10, v3, vcc
    v_cndmask_b32 v4, v10, v4, vcc
    v_mov_b32 v9, 0
    v_mov_b32 v166, 1
    s_cmp_lg_u32 s3, 7
    s_cbranch_scc1 L_nocp
    s_getpc_b64 s[40:41]
L_pc:
    s_sub_u32 s40, s40, L_pc-gated_mix__gqa_block_cached__dense_activation_mish__decode_kernel
    s_subb_u32 s41, s41, 0
    s_lshr_b32 s82, s2, 3
    s_mul_i32 s82, s82, 640
    v_lshl_add_u32 v10, v1, 7, s82
    v_min_u32 v10, L_codeend-gated_mix__gqa_block_cached__dense_activation_mish__decode_kernel-4, v10
    s_mov_b64 exec, 31
    global_load_dword v165, v10, s[40:41]
    s_mov_b64 exec, -1
L_nocp:
    s_barrier
    s_waitcnt vmcnt(2)
    s_add_u32 s85, s88, 1
    s_and_b32 s85, s85, 7
    s_mul_i32 s86, s85, 196608
    buffer_load_dwordx4 v[48:51], v2, s[32:35], s86 offen offset:0 nt
    s_mov_b64 exec, 1
    ds_add_rtn_u32 v0, v166, v166 offset:28803
    s_mov_b64 exec, -1
    s_waitcnt vmcnt(2)
    buffer_load_dwordx4 v[52:55], v2, s[32:35], s86 offen offset:128 nt
    s_mov_b64 exec, 1
    ds_add_rtn_u32 v0, v166, v166 offset:28803
    s_mov_b64 exec, -1
    s_waitcnt vmcnt(2)
    buffer_load_dwordx4 v[56:59], v2, s[32:35], s86 offen offset:256 nt
    s_mov_b64 exec, 1
    ds_add_rtn_u32 v0, v166, v166 offset:28803
    s_mov_b64 exec, -1
    s_waitcnt lgkmcnt(0)
    v_readfirstlane_b32 s90, v0
    s_cmp_lt_i32 s90, 52
    s_cbranch_scc0 L_go4
    s_waitcnt vmcnt(2)
    s_cmp_lt_i32 s90, 35
    s_cbranch_scc0 L_go4
    s_waitcnt vmcnt(1)
L_go4:
    s_add_u32 s85, s88, 2
    s_and_b32 s85, s85, 7
    s_mul_i32 s86, s85, 196608
    buffer_load_dwordx4 v[60:63], v2, s[32:35], s86 offen offset:0 nt
    s_mov_b64 exec, 1
    ds_add_rtn_u32 v0, v166, v166 offset:28803
    s_mov_b64 exec, -1
    s_waitcnt vmcnt(3)
    s_waitcnt lgkmcnt(0)
    v_readfirstlane_b32 s90, v0
    s_cmp_lt_i32 s90, 60
    s_cbranch_scc0 L_go5
    s_waitcnt vmcnt(2)
    s_cmp_lt_i32 s90, 43
    s_cbranch_scc0 L_go5
    s_waitcnt vmcnt(1)
L_go5:
    buffer_load_dwordx4 v[64:67], v2, s[32:35], s86 offen offset:128 nt
    s_mov_b64 exec, 1
    ds_add_rtn_u32 v0, v166, v166 offset:28803
    s_mov_b64 exec, -1
    s_waitcnt vmcnt(3)
    s_waitcnt lgkmcnt(0)
    v_readfirstlane_b32 s90, v0
    s_cmp_lt_i32 s90, 68
    s_cbranch_scc0 L_go6
    s_waitcnt vmcnt(2)
    s_cmp_lt_i32 s90, 51
    s_cbranch_scc0 L_go6
    s_waitcnt vmcnt(1)
L_go6:
    buffer_load_dwordx4 v[68:71], v2, s[32:35], s86 offen offset:256 nt
    s_mov_b64 exec, 1
    ds_add_rtn_u32 v0, v166, v166 offset:28803
    s_mov_b64 exec, -1
    s_waitcnt vmcnt(3)
    s_waitcnt lgkmcnt(0)
    v_readfirstlane_b32 s90, v0
    s_cmp_lt_i32 s90, 76
    s_cbranch_scc0 L_go7
    s_waitcnt vmcnt(2)
    s_cmp_lt_i32 s90, 59
    s_cbranch_scc0 L_go7
    s_waitcnt vmcnt(1)
L_go7:
    s_add_u32 s85, s88, 3
    s_and_b32 s85, s85, 7
    s_mul_i32 s86, s85, 196608
    buffer_load_dwordx4 v[72:75], v2, s[32:35], s86 offen offset:0 nt
    s_mov_b64 exec, 1
    ds_add_rtn_u32 v0, v166, v166 offset:28803
    s_mov_b64 exec, -1
    s_waitcnt vmcnt(3)
    s_waitcnt lgkmcnt(0)
    v_readfirstlane_b32 s90, v0
    s_cmp_lt_i32 s90, 84
    s_cbranch_scc0 L_go8
    s_waitcnt vmcnt(2)
    s_cmp_lt_i32 s90, 67
    s_cbranch_scc0 L_go8
    s_waitcnt vmcnt(1)
L_go8:
    buffer_load_dwordx4 v[76:79], v2, s[32:35], s86 offen offset:128 nt
    s_mov_b64 exec, 1
    ds_add_rtn_u32 v0, v166, v166 offset:28803
    s_mov_b64 exec, -1
    s_waitcnt vmcnt(3)
    s_waitcnt lgkmcnt(0)
    v_readfirstlane_b32 s90, v0
    s_cmp_lt_i32 s90, 92
    s_cbranch_scc0 L_go9
    s_waitcnt vmcnt(2)
    s_cmp_lt_i32 s90, 75
    s_cbranch_scc0 L_go9
    s_waitcnt vmcnt(1)
L_go9:
    buffer_load_dwordx4 v[80:83], v2, s[32:35], s86 offen offset:256 nt
    s_mov_b64 exec, 1
    ds_add_rtn_u32 v0, v166, v166 offset:28803
    s_mov_b64 exec, -1
    s_waitcnt vmcnt(3)
    s_waitcnt lgkmcnt(0)
    v_readfirstlane_b32 s90, v0
    s_cmp_lt_i32 s90, 100
    s_cbranch_scc0 L_go10
    s_waitcnt vmcnt(2)
    s_cmp_lt_i32 s90, 83
    s_cbranch_scc0 L_go10
    s_waitcnt vmcnt(1)
L_go10:
    s_add_u32 s85, s88, 4
    s_and_b32 s85, s85, 7
    s_mul_i32 s86, s85, 196608
    buffer_load_dwordx4 v[84:87], v2, s[32:35], s86 offen offset:0 nt
    s_mov_b64 exec, 1
    ds_add_rtn_u32 v0, v166, v166 offset:28803
    s_mov_b64 exec, -1
    s_waitcnt vmcnt(3)
    s_waitcnt lgkmcnt(0)
    v_readfirstlane_b32 s90, v0
    s_cmp_lt_i32 s90, 108
    s_cbranch_scc0 L_go11
    s_waitcnt vmcnt(2)
    s_cmp_lt_i32 s90, 91
    s_cbranch_scc0 L_go11
    s_waitcnt vmcnt(1)
L_go11:
    buffer_load_dwordx4 v[88:91], v2, s[32:35], s86 offen offset:128 nt
    s_mov_b64 exec, 1
    ds_add_rtn_u32 v0, v166, v166 offset:28803
    s_mov_b64 exec, -1
    s_waitcnt vmcnt(3)
    s_waitcnt lgkmcnt(0)
    v_readfirstlane_b32 s90, v0
    s_cmp_lt_i32 s90, 116
    s_cbranch_scc0 L_go12
    s_waitcnt vmcnt(2)
    s_cmp_lt_i32 s90, 99
    s_cbranch_scc0 L_go12
    s_waitcnt vmcnt(1)
L_go12:
    buffer_load_dwordx4 v[92:95], v2, s[32:35], s86 offen offset:256 nt
    s_mov_b64 exec, 1
    ds_add_rtn_u32 v0, v166, v166 offset:28803
    s_mov_b64 exec, -1
    s_waitcnt vmcnt(3)
    s_waitcnt lgkmcnt(0)
    v_readfirstlane_b32 s90, v0
    s_cmp_lt_i32 s90, 124
    s_cbranch_scc0 L_go13
    s_waitcnt vmcnt(2)
    s_cmp_lt_i32 s90, 107
    s_cbranch_scc0 L_go13
    s_waitcnt vmcnt(1)
L_go13:
    s_add_u32 s85, s88, 5
    s_and_b32 s85, s85, 7
    s_mul_i32 s86, s85, 196608
    buffer_load_dwordx4 v[96:99], v2, s[32:35], s86 offen offset:0 nt
    s_mov_b64 exec, 1
    ds_add_rtn_u32 v0, v166, v166 offset:28803
    s_mov_b64 exec, -1
    s_waitcnt vmcnt(3)
    s_waitcnt lgkmcnt(0)
    v_readfirstlane_b32 s90, v0
    s_cmp_lt_i32 s90, 132
    s_cbranch_scc0 L_go14
    s_waitcnt vmcnt(2)
    s_cmp_lt_i32 s90, 115
    s_cbranch_scc0 L_go14
    s_waitcnt vmcnt(1)
L_go14:
    buffer_load_dwordx4 v[100:103], v2, s[32:35], s86 offen offset:128 nt
    s_mov_b64 exec, 1
    ds_add_rtn_u32 v0, v166, v166 offset:28803
    s_mov_b64 exec, -1
    s_waitcnt vmcnt(3)
    s_waitcnt lgkmcnt(0)
    v_readfirstlane_b32 s90, v0
    s_cmp_lt_i32 s90, 140
    s_cbranch_scc0 L_go15
    s_waitcnt vmcnt(2)
    s_cmp_lt_i32 s90, 123
    s_cbranch_scc0 L_go15
    s_waitcnt vmcnt(1)
L_go15:
    buffer_load_dwordx4 v[104:107], v2, s[32:35], s86 offen offset:256 nt
    s_mov_b64 exec, 1
    ds_add_rtn_u32 v0, v166, v166 offset:28803
    s_mov_b64 exec, -1
    s_waitcnt vmcnt(3)
    s_waitcnt lgkmcnt(0)
    v_readfirstlane_b32 s90, v0
    s_cmp_lt_i32 s90, 148
    s_cbranch_scc0 L_go16
    s_waitcnt vmcnt(2)
    s_cmp_lt_i32 s90, 131
    s_cbranch_scc0 L_go16
    s_waitcnt vmcnt(1)
L_go16:
    s_add_u32 s85, s88, 6
    s_and_b32 s85, s85, 7
    s_mul_i32 s86, s85, 196608
    buffer_load_dwordx4 v[108:111], v2, s[32:35], s86 offen offset:0 nt
    s_mov_b64 exec, 1
    ds_add_rtn_u32 v0, v166, v166 offset:28803
    s_mov_b64 exec, -1
    s_waitcnt vmcnt(3)
    s_waitcnt lgkmcnt(0)
    v_readfirstlane_b32 s90, v0
    s_cmp_lt_i32 s90, 156
    s_cbranch_scc0 L_go17
    s_waitcnt vmcnt(2)
    s_cmp_lt_i32 s90, 139
    s_cbranch_scc0 L_go17
    s_waitcnt vmcnt(1)
L_go17:
    buffer_load_dwordx4 v[112:115], v2, s[32:35], s86 offen offset:128 nt
    s_mov_b64 exec, 1
    ds_add_rtn_u32 v0, v166, v166 offset:28803
    s_mov_b64 exec, -1
    s_waitcnt vmcnt(3)
    s_waitcnt lgkmcnt(0)
    v_readfirstlane_b32 s90, v0
    s_cmp_lt_i32 s90, 164
    s_cbranch_scc0 L_go18
    s_waitcnt vmcnt(2)
    s_cmp_lt_i32 s90, 147
    s_cbranch_scc0 L_go18
    s_waitcnt vmcnt(1)
L_go18:
    buffer_load_dwordx4 v[116:119], v2, s[32:35], s86 offen offset:256 nt
    s_mov_b64 exec, 1
    ds_add_rtn_u32 v0, v166, v166 offset:28803
    s_mov_b64 exec, -1
    s_waitcnt vmcnt(3)
    s_waitcnt lgkmcnt(0)
    v_readfirstlane_b32 s90, v0
    s_cmp_lt_i32 s90, 172
    s_cbranch_scc0 L_go19
    s_waitcnt vmcnt(2)
    s_cmp_lt_i32 s90, 155
    s_cbranch_scc0 L_go19
    s_waitcnt vmcnt(1)
L_go19:
    s_add_u32 s85, s88, 7
    s_and_b32 s85, s85, 7
    s_mul_i32 s86, s85, 196608
    buffer_load_dwordx4 v[120:123], v2, s[32:35], s86 offen offset:0 nt
    s_mov_b64 exec, 1
    ds_add_rtn_u32 v0, v166, v166 offset:28803
    s_mov_b64 exec, -1
    s_waitcnt vmcnt(3)
    s_waitcnt lgkmcnt(0)
    v_readfirstlane_b32 s90, v0
    s_cmp_lt_i32 s90, 180
    s_cbranch_scc0 L_go20
    s_waitcnt vmcnt(2)
    s_cmp_lt_i32 s90, 163
    s_cbranch_scc0 L_go20
    s_waitcnt vmcnt(1)
L_go20:
    buffer_load_dwordx4 v[124:127], v2, s[32:35], s86 offen offset:128 nt
    s_mov_b64 exec, 1
    ds_add_rtn_u32 v0, v166, v166 offset:28803
    s_mov_b64 exec, -1
    s_waitcnt vmcnt(3)
    s_waitcnt lgkmcnt(0)
    v_readfirstlane_b32 s90, v0
    s_cmp_lt_i32 s90, 188
    s_cbranch_scc0 L_go21
    s_waitcnt vmcnt(2)
    s_cmp_lt_i32 s90, 171
    s_cbranch_scc0 L_go21
    s_waitcnt vmcnt(1)
L_go21:
    buffer_load_dwordx4 v[128:131], v2, s[32:35], s86 offen offset:256 nt
    s_mov_b64 exec, 1
    ds_add_rtn_u32 v0, v166, v166 offset:28803
    s_mov_b64 exec, -1
    s_waitcnt vmcnt(3)
    s_waitcnt lgkmcnt(0)
    v_readfirstlane_b32 s90, v0
    s_cmp_lt_i32 s90, 196
    s_cbranch_scc0 L_go22
    s_waitcnt vmcnt(2)
    s_cmp_lt_i32 s90, 179
    s_cbranch_scc0 L_go22
    s_waitcnt vmcnt(1)
L_go22:
    s_add_u32 s85, s88, 0
    s_and_b32 s85, s85, 7
    s_mul_i32 s86, s85, 196608
    s_add_u32 s86, s86, 50331648
    buffer_load_dwordx4 v[132:135], v2, s[32:35], s86 offen offset:0 nt
    s_mov_b64 exec, 1
    ds_add_rtn_u32 v0, v166, v166 offset:28803
    s_mov_b64 exec, -1
    s_waitcnt vmcnt(3)
    s_waitcnt lgkmcnt(0)
    v_readfirstlane_b32 s90, v0
    s_cmp_lt_i32 s90, 204
    s_cbranch_scc0 L_go23
    s_waitcnt vmcnt(2)
    s_cmp_lt_i32 s90, 187
    s_cbranch_scc0 L_go23
    s_waitcnt vmcnt(1)
L_go23:
    buffer_load_dwordx4 v[136:139], v2, s[32:35], s86 offen offset:128 nt
    s_mov_b64 exec, 1
    ds_add_rtn_u32 v0, v166, v166 offset:28803
    s_mov_b64 exec, -1
    s_waitcnt vmcnt(3)
    s_waitcnt lgkmcnt(0)
    v_readfirstlane_b32 s90, v0
    s_cmp_lt_i32 s90, 212
    s_cbranch_scc0 L_go24
    s_waitcnt vmcnt(2)
    s_cmp_lt_i32 s90, 195
    s_cbranch_scc0 L_go24
    s_waitcnt vmcnt(1)
L_go24:
    buffer_load_dwordx4 v[140:143], v2, s[32:35], s86 offen offset:256 nt
    s_mov_b64 exec, 1
    ds_add_rtn_u32 v0, v166, v166 offset:28803
    s_mov_b64 exec, -1
    s_waitcnt vmcnt(3)
    s_waitcnt lgkmcnt(0)
    v_readfirstlane_b32 s90, v0
    s_cmp_lt_i32 s90, 220
    s_cbranch_scc0 L_go25
    s_waitcnt vmcnt(2)
    s_cmp_lt_i32 s90, 203
    s_cbranch_scc0 L_go25
    s_waitcnt vmcnt(1)
L_go25:
    s_add_u32 s85, s88, 1
    s_and_b32 s85, s85, 7
    s_mul_i32 s86, s85, 196608
    s_add_u32 s86, s86, 50331648
    buffer_load_dwordx4 v[144:147], v2, s[32:35], s86 offen offset:0 nt
    s_mov_b64 exec, 1
    ds_add_rtn_u32 v0, v166, v166 offset:28803
    s_mov_b64 exec, -1
    s_waitcnt vmcnt(3)
    s_waitcnt lgkmcnt(0)
    v_readfirstlane_b32 s90, v0
    s_cmp_lt_i32 s90, 228
    s_cbranch_scc0 L_go26
    s_waitcnt vmcnt(2)
    s_cmp_lt_i32 s90, 211
    s_cbranch_scc0 L_go26
    s_waitcnt vmcnt(1)
L_go26:
    buffer_load_dwordx4 v[148:151], v2, s[32:35], s86 offen offset:128 nt
    s_mov_b64 exec, 1
    ds_add_rtn_u32 v0, v166, v166 offset:28803
    s_mov_b64 exec, -1
    s_waitcnt vmcnt(3)
    s_waitcnt lgkmcnt(0)
    v_readfirstlane_b32 s90, v0
    s_cmp_lt_i32 s90, 236
    s_cbranch_scc0 L_go27
    s_waitcnt vmcnt(2)
    s_cmp_lt_i32 s90, 219
    s_cbranch_scc0 L_go27
    s_waitcnt vmcnt(1)
L_go27:
    buffer_load_dwordx4 v[152:155], v2, s[32:35], s86 offen offset:256 nt
    s_mov_b64 exec, 1
    ds_add_rtn_u32 v0, v166, v166 offset:28803
    s_mov_b64 exec, -1
    s_waitcnt lgkmcnt(0)
    s_add_u32 s79, s79, 1
    s_and_b32 s78, s79, 1023
L_qw:
    ds_read_b32 v8, v9 offset:28800
    ds_read_b128 v[24:27], v5 offset:27136
    ds_read_b128 v[28:31], v5 offset:27264
    ds_read_b128 v[32:35], v5 offset:27392
    s_waitcnt lgkmcnt(0)
    v_readfirstlane_b32 s89, v8
    s_cmp_lg_u32 s89, 0
    s_cbranch_scc1 L_qwd
    s_sleep 2
    s_sub_u32 s92, s92, 1
    s_cbranch_scc0 L_qw
    s_endpgm
L_qwd:
    s_waitcnt vmcnt(3)
    s_waitcnt lgkmcnt(0)
    v_readfirstlane_b32 s90, v0
    s_cmp_lt_i32 s90, 244
    s_cbranch_scc0 L_go28
    s_waitcnt vmcnt(2)
    s_cmp_lt_i32 s90, 227
    s_cbranch_scc0 L_go28
    s_waitcnt vmcnt(1)
L_go28:
    s_add_u32 s85, s88, 2
    s_and_b32 s85, s85, 7
    s_mul_i32 s86, s85, 196608
    s_add_u32 s86, s86, 50331648
    buffer_load_dwordx4 v[156:159], v2, s[32:35], s86 offen offset:0 nt
    s_mov_b64 exec, 1
    ds_add_rtn_u32 v0, v166, v166 offset:28803
    s_mov_b64 exec, -1
    v_dot2_f32_bf16 v8, v36, v24, 0
    v_dot2_f32_bf16 v8, v37, v25, v8
    v_dot2_f32_bf16 v8, v38, v26, v8
    v_dot2_f32_bf16 v8, v39, v27, v8
    v_dot2_f32_bf16 v8, v40, v28, v8
    v_dot2_f32_bf16 v8, v41, v29, v8
    v_dot2_f32_bf16 v8, v42, v30, v8
    v_dot2_f32_bf16 v8, v43, v31, v8
    v_dot2_f32_bf16 v8, v44, v32, v8
    v_dot2_f32_bf16 v8, v45, v33, v8
    v_dot2_f32_bf16 v8, v46, v34, v8
    v_dot2_f32_bf16 v8, v47, v35, v8
    v_dot2_f32_bf16 v9, v48, v24, 0
    v_dot2_f32_bf16 v9, v49, v25, v9
    v_dot2_f32_bf16 v9, v50, v26, v9
    v_dot2_f32_bf16 v9, v51, v27, v9
    v_dot2_f32_bf16 v9, v52, v28, v9
    v_dot2_f32_bf16 v9, v53, v29, v9
    v_dot2_f32_bf16 v9, v54, v30, v9
    v_dot2_f32_bf16 v9, v55, v31, v9
    v_dot2_f32_bf16 v9, v56, v32, v9
    v_dot2_f32_bf16 v9, v57, v33, v9
    v_dot2_f32_bf16 v9, v58, v34, v9
    v_dot2_f32_bf16 v9, v59, v35, v9
    s_waitcnt vmcnt(3)
    s_waitcnt lgkmcnt(0)
    v_readfirstlane_b32 s90, v0
    s_cmp_lt_i32 s90, 252
    s_cbranch_scc0 L_go29
    s_waitcnt vmcnt(2)
    s_cmp_lt_i32 s90, 235
    s_cbranch_scc0 L_go29
    s_waitcnt vmcnt(1)
L_go29:
    buffer_load_dwordx4 v[160:163], v2, s[32:35], s86 offen offset:128 nt
    s_mov_b64 exec, 1
    ds_add_rtn_u32 v0, v166, v166 offset:28803
    s_mov_b64 exec, -1
    v_dot2_f32_bf16 v10, v60, v24, 0
    v_dot2_f32_bf16 v10, v61, v25, v10
    v_dot2_f32_bf16 v10, v62, v26, v10
    v_dot2_f32_bf16 v10, v63, v27, v10
    v_dot2_f32_bf16 v10, v64, v28, v10
    v_dot2_f32_bf16 v10, v65, v29, v10
    v_dot2_f32_bf16 v10, v66, v30, v10
    v_dot2_f32_bf16 v10, v67, v31, v10
    v_dot2_f32_bf16 v10, v68, v32, v10
    v_dot2_f32_bf16 v10, v69, v33, v10
    v_dot2_f32_bf16 v10, v70, v34, v10
    v_dot2_f32_bf16 v10, v71, v35, v10
    v_dot2_f32_bf16 v11, v72, v24, 0
    v_dot2_f32_bf16 v11, v73, v25, v11
    v_dot2_f32_bf16 v11, v74, v26, v11
    v_dot2_f32_bf16 v11, v75, v27, v11
    v_dot2_f32_bf16 v11, v76, v28, v11
    v_dot2_f32_bf16 v11, v77, v29, v11
    v_dot2_f32_bf16 v11, v78, v30, v11
    v_dot2_f32_bf16 v11, v79, v31, v11
    v_dot2_f32_bf16 v11, v80, v32, v11
    v_dot2_f32_bf16 v11, v81, v33, v11
    v_dot2_f32_bf16 v11, v82, v34, v11
    v_dot2_f32_bf16 v11, v83, v35, v11
    s_waitcnt vmcnt(3)
    s_waitcnt lgkmcnt(0)
    v_readfirstlane_b32 s90, v0
    s_cmp_lt_i32 s90, 260
    s_cbranch_scc0 L_go30
    s_waitcnt vmcnt(2)
    s_cmp_lt_i32 s90, 243
    s_cbranch_scc0 L_go30
    s_waitcnt vmcnt(1)
L_go30:
    buffer_load_dwordx4 v[76:79], v2, s[32:35], s86 offen offset:256 nt
    s_mov_b64 exec, 1
    ds_add_rtn_u32 v0, v166, v166 offset:28803
    s_mov_b64 exec, -1
    v_dot2_f32_bf16 v12, v84, v24, 0
    v_dot2_f32_bf16 v12, v85, v25, v12
    v_dot2_f32_bf16 v12, v86, v26, v12
    v_dot2_f32_bf16 v12, v87, v27, v12
    v_dot2_f32_bf16 v12, v88, v28, v12
    v_dot2_f32_bf16 v12, v89, v29, v12
    v_dot2_f32_bf16 v12, v90, v30, v12
    v_dot2_f32_bf16 v12, v91, v31, v12
    v_dot2_f32_bf16 v12, v92, v32, v12
    v_dot2_f32_bf16 v12, v93, v33, v12
    v_dot2_f32_bf16 v12, v94, v34, v12
    v_dot2_f32_bf16 v12, v95, v35, v12
    v_dot2_f32_bf16 v13, v96, v24, 0
    v_dot2_f32_bf16 v13, v97, v25, v13
    v_dot2_f32_bf16 v13, v98, v26, v13
    v_dot2_f32_bf16 v13, v99, v27, v13
    v_dot2_f32_bf16 v13, v100, v28, v13
    v_dot2_f32_bf16 v13, v101, v29, v13
    v_dot2_f32_bf16 v13, v102, v30, v13
    v_dot2_f32_bf16 v13, v103, v31, v13
    v_dot2_f32_bf16 v13, v104, v32, v13
    v_dot2_f32_bf16 v13, v105, v33, v13
    v_dot2_f32_bf16 v13, v106, v34, v13
    v_dot2_f32_bf16 v13, v107, v35, v13
    s_waitcnt vmcnt(3)
    s_waitcnt lgkmcnt(0)
    v_readfirstlane_b32 s90, v0
    s_cmp_lt_i32 s90, 268
    s_cbranch_scc0 L_go31
    s_waitcnt vmcnt(2)
    s_cmp_lt_i32 s90, 251
    s_cbranch_scc0 L_go31
    s_waitcnt vmcnt(1)
L_go31:
    s_add_u32 s85, s88, 3
    s_and_b32 s85, s85, 7
    s_mul_i32 s86, s85, 196608
    s_add_u32 s86, s86, 50331648
    buffer_load_dwordx4 v[80:83], v2, s[32:35], s86 offen offset:0 nt
    s_mov_b64 exec, 1
    ds_add_rtn_u32 v0, v166, v166 offset:28803
    s_mov_b64 exec, -1
    v_dot2_f32_bf16 v14, v108, v24, 0
    v_dot2_f32_bf16 v14, v109, v25, v14
    v_dot2_f32_bf16 v14, v110, v26, v14
    v_dot2_f32_bf16 v14, v111, v27, v14
    v_dot2_f32_bf16 v14, v112, v28, v14
    v_dot2_f32_bf16 v14, v113, v29, v14
    v_dot2_f32_bf16 v14, v114, v30, v14
    v_dot2_f32_bf16 v14, v115, v31, v14
    v_dot2_f32_bf16 v14, v116, v32, v14
    v_dot2_f32_bf16 v14, v117, v33, v14
    v_dot2_f32_bf16 v14, v118, v34, v14
    v_dot2_f32_bf16 v14, v119, v35, v14
    v_dot2_f32_bf16 v15, v120, v24, 0
    v_dot2_f32_bf16 v15, v121, v25, v15
    v_dot2_f32_bf16 v15, v122, v26, v15
    v_dot2_f32_bf16 v15, v123, v27, v15
    v_dot2_f32_bf16 v15, v124, v28, v15
    v_dot2_f32_bf16 v15, v125, v29, v15
    v_dot2_f32_bf16 v15, v126, v30, v15
    v_dot2_f32_bf16 v15, v127, v31, v15
    v_dot2_f32_bf16 v15, v128, v32, v15
    v_dot2_f32_bf16 v15, v129, v33, v15
    v_dot2_f32_bf16 v15, v130, v34, v15
    v_dot2_f32_bf16 v15, v131, v35, v15
    ds_read_b128 v[24:27], v5 offset:27648
    ds_read_b128 v[28:31], v5 offset:27776
    ds_read_b128 v[32:35], v5 offset:27904
    s_waitcnt vmcnt(3)
    s_waitcnt lgkmcnt(0)
    v_readfirstlane_b32 s90, v0
    s_cmp_lt_i32 s90, 276
    s_cbranch_scc0 L_go32
    s_waitcnt vmcnt(2)
    s_cmp_lt_i32 s90, 259
    s_cbranch_scc0 L_go32
    s_waitcnt vmcnt(1)
L_go32:
    buffer_load_dwordx4 v[84:87], v2, s[32:35], s86 offen offset:128 nt
    s_mov_b64 exec, 1
    ds_add_rtn_u32 v0, v166, v166 offset:28803
    s_mov_b64 exec, -1
    s_waitcnt lgkmcnt(0)
    v_dot2_f32_bf16 v16, v132, v24, 0
    v_dot2_f32_bf16 v16, v133, v25, v16
    v_dot2_f32_bf16 v16, v134, v26, v16
    v_dot2_f32_bf16 v16, v135, v27, v16
    v_dot2_f32_bf16 v16, v136, v28, v16
    v_dot2_f32_bf16 v16, v137, v29, v16
    v_dot2_f32_bf16 v16, v138, v30, v16
    v_dot2_f32_bf16 v16, v139, v31, v16
    v_dot2_f32_bf16 v16, v140, v32, v16
    v_dot2_f32_bf16 v16, v141, v33, v16
    v_dot2_f32_bf16 v16, v142, v34, v16
    v_dot2_f32_bf16 v16, v143, v35, v16
    v_dot2_f32_bf16 v17, v144, v24, 0
    v_dot2_f32_bf16 v17, v145, v25, v17
    v_dot2_f32_bf16 v17, v146, v26, v17
    v_dot2_f32_bf16 v17, v147, v27, v17
    v_dot2_f32_bf16 v17, v148, v28, v17
    v_dot2_f32_bf16 v17, v149, v29, v17
    v_dot2_f32_bf16 v17, v150, v30, v17
    v_dot2_f32_bf16 v17, v151, v31, v17
    v_dot2_f32_bf16 v17, v152, v32, v17
    v_dot2_f32_bf16 v17, v153, v33, v17
    v_dot2_f32_bf16 v17, v154, v34, v17
    v_dot2_f32_bf16 v17, v155, v35, v17
    s_waitcnt vmcnt(3)
    s_waitcnt lgkmcnt(0)
    v_readfirstlane_b32 s90, v0
    s_cmp_lt_i32 s90, 284
    s_cbranch_scc0 L_go33
    s_waitcnt vmcnt(2)
    s_cmp_lt_i32 s90, 267
    s_cbranch_scc0 L_go33
    s_waitcnt vmcnt(1)
L_go33:
    buffer_load_dwordx4 v[88:91], v2, s[32:35], s86 offen offset:256 nt
    s_mov_b64 exec, 1
    ds_add_rtn_u32 v0, v166, v166 offset:28803
    s_mov_b64 exec, -1
    s_waitcnt vmcnt(3)
    s_waitcnt lgkmcnt(0)
    v_readfirstlane_b32 s90, v0
    s_cmp_lt_i32 s90, 292
    s_cbranch_scc0 L_go34
    s_waitcnt vmcnt(2)
    s_cmp_lt_i32 s90, 275
    s_cbranch_scc0 L_go34
    s_waitcnt vmcnt(1)
L_go34:
    s_add_u32 s85, s88, 4
    s_and_b32 s85, s85, 7
    s_mul_i32 s86, s85, 196608
    s_add_u32 s86, s86, 50331648
    buffer_load_dwordx4 v[92:95], v2, s[32:35], s86 offen offset:0 nt
    s_mov_b64 exec, 1
    ds_add_rtn_u32 v0, v166, v166 offset:28803
    s_mov_b64 exec, -1
    v_dot2_f32_bf16 v18, v156, v24, 0
    v_dot2_f32_bf16 v18, v157, v25, v18
    v_dot2_f32_bf16 v18, v158, v26, v18
    v_dot2_f32_bf16 v18, v159, v27, v18
    v_dot2_f32_bf16 v18, v160, v28, v18
    v_dot2_f32_bf16 v18, v161, v29, v18
    v_dot2_f32_bf16 v18, v162, v30, v18
    v_dot2_f32_bf16 v18, v163, v31, v18
    v_dot2_f32_bf16 v18, v76, v32, v18
    v_dot2_f32_bf16 v18, v77, v33, v18
    v_dot2_f32_bf16 v18, v78, v34, v18
    v_dot2_f32_bf16 v18, v79, v35, v18
    v_lshrrev_b32 v62, 5, v1
    s_lshl_b32 s82, s3, 1
    v_add_u32 v62, s82, v62
    v_lshlrev_b32 v63, 5, v7
    v_bfe_u32 v64, v1, 4, 1
    v_lshl_add_u32 v63, v64, 4, v63
    v_mul_u32_u24 v48, 848, v62
    v_add_u32 v48, v48, v63
    v_and_b32 v62, 1, v1
    v_lshlrev_b32 v62, 4, v62
    v_mov_b32 v63, 0xffff
    v_lshlrev_b32 v62, v62, v63
    v_bfe_u32 v63, v1, 1, 2
    v_cmp_eq_u32 vcc, 0, v63
    s_nop 1
    v_cndmask_b32 v36, 0, v62, vcc
    v_cmp_eq_u32 vcc, 1, v63
    s_nop 1
    v_cndmask_b32 v37, 0, v62, vcc
    v_cmp_eq_u32 vcc, 2, v63
    s_nop 1
    v_cndmask_b32 v38, 0, v62, vcc
    v_cmp_eq_u32 vcc, 3, v63
    s_nop 1
    v_cndmask_b32 v39, 0, v62, vcc
    s_waitcnt vmcnt(3)
    s_waitcnt lgkmcnt(0)
    v_readfirstlane_b32 s90, v0
    s_cmp_lt_i32 s90, 300
    s_cbranch_scc0 L_go35
    s_waitcnt vmcnt(2)
    s_cmp_lt_i32 s90, 283
    s_cbranch_scc0 L_go35
    s_waitcnt vmcnt(1)
L_go35:
    buffer_load_dwordx4 v[96:99], v2, s[32:35], s86 offen offset:128 nt
    s_mov_b64 exec, 1
    ds_add_rtn_u32 v0, v166, v166 offset:28803
    s_mov_b64 exec, -1
    v_add_f32_dpp v8, v8, v8 quad_perm:[1,0,3,2] row_mask:0xf bank_mask:0xf
    v_add_f32_dpp v9, v9, v9 quad_perm:[1,0,3,2] row_mask:0xf bank_mask:0xf
    v_add_f32_dpp v10, v10, v10 quad_perm:[1,0,3,2] row_mask:0xf bank_mask:0xf
    v_add_f32_dpp v11, v11, v11 quad_perm:[1,0,3,2] row_mask:0xf bank_mask:0xf
    v_add_f32_dpp v12, v12, v12 quad_perm:[1,0,3,2] row_mask:0xf bank_mask:0xf
    v_add_f32_dpp v13, v13, v13 quad_perm:[1,0,3,2] row_mask:0xf bank_mask:0xf
    v_add_f32_dpp v14, v14, v14 quad_perm:[1,0,3,2] row_mask:0xf bank_mask:0xf
    v_add_f32_dpp v15, v15, v15 quad_perm:[1,0,3,2] row_mask:0xf bank_mask:0xf
    v_add_f32_dpp v8, v8, v8 quad_perm:[2,3,0,1] row_mask:0xf bank_mask:0xf
    v_add_f32_dpp v9, v9, v9 quad_perm:[2,3,0,1] row_mask:0xf bank_mask:0xf
    v_add_f32_dpp v10, v10, v10 quad_perm:[2,3,0,1] row_mask:0xf bank_mask:0xf
    v_add_f32_dpp v11, v11, v11 quad_perm:[2,3,0,1] row_mask:0xf bank_mask:0xf
    v_add_f32_dpp v12, v12, v12 quad_perm:[2,3,0,1] row_mask:0xf bank_mask:0xf
    v_add_f32_dpp v13, v13, v13 quad_perm:[2,3,0,1] row_mask:0xf bank_mask:0xf
    v_add_f32_dpp v14, v14, v14 quad_perm:[2,3,0,1] row_mask:0xf bank_mask:0xf
    v_add_f32_dpp v15, v15, v15 quad_perm:[2,3,0,1] row_mask:0xf bank_mask:0xf
    v_add_f32_dpp v8, v8, v8 row_half_mirror row_mask:0xf bank_mask:0xf
    v_add_f32_dpp v9, v9, v9 row_half_mirror row_mask:0xf bank_mask:0xf
    v_add_f32_dpp v10, v10, v10 row_half_mirror row_mask:0xf bank_mask:0xf
    v_add_f32_dpp v11, v11, v11 row_half_mirror row_mask:0xf bank_mask:0xf
    v_add_f32_dpp v12, v12, v12 row_half_mirror row_mask:0xf bank_mask:0xf
    v_add_f32_dpp v13, v13, v13 row_half_mirror row_mask:0xf bank_mask:0xf
    v_add_f32_dpp v14, v14, v14 row_half_mirror row_mask:0xf bank_mask:0xf
    v_add_f32_dpp v15, v15, v15 row_half_mirror row_mask:0xf bank_mask:0xf
    s_waitcnt vmcnt(3)
    s_waitcnt lgkmcnt(0)
    v_readfirstlane_b32 s90, v0
    s_cmp_lt_i32 s90, 308
    s_cbranch_scc0 L_go36
    s_waitcnt vmcnt(2)
    s_cmp_lt_i32 s90, 291
    s_cbranch_scc0 L_go36
    s_waitcnt vmcnt(1)
L_go36:
    buffer_load_dwordx4 v[100:103], v2, s[32:35], s86 offen offset:256 nt
    s_mov_b64 exec, 1
    ds_add_rtn_u32 v0, v166, v166 offset:28803
    s_mov_b64 exec, -1
    s_waitcnt vmcnt(3)
    s_waitcnt lgkmcnt(0)
    v_readfirstlane_b32 s90, v0
    s_cmp_lt_i32 s90, 316
    s_cbranch_scc0 L_go37
    s_waitcnt vmcnt(2)
    s_cmp_lt_i32 s90, 299
    s_cbranch_scc0 L_go37
    s_waitcnt vmcnt(1)
L_go37:
    s_add_u32 s85, s88, 5
    s_and_b32 s85, s85, 7
    s_mul_i32 s86, s85, 196608
    s_add_u32 s86, s86, 50331648
    buffer_load_dwordx4 v[104:107], v2, s[32:35], s86 offen offset:0 nt
    s_mov_b64 exec, 1
    ds_add_rtn_u32 v0, v166, v166 offset:28803
    s_mov_b64 exec, -1
    v_dot2_f32_bf16 v19, v80, v24, 0
    v_dot2_f32_bf16 v19, v81, v25, v19
    v_dot2_f32_bf16 v19, v82, v26, v19
    v_dot2_f32_bf16 v19, v83, v27, v19
    v_dot2_f32_bf16 v19, v84, v28, v19
    v_dot2_f32_bf16 v19, v85, v29, v19
    v_dot2_f32_bf16 v19, v86, v30, v19
    v_dot2_f32_bf16 v19, v87, v31, v19
    v_dot2_f32_bf16 v19, v88, v32, v19
    v_dot2_f32_bf16 v19, v89, v33, v19
    v_dot2_f32_bf16 v19, v90, v34, v19
    v_dot2_f32_bf16 v19, v91, v35, v19
    v_cvt_pk_bf16_f32 v8, v8, v9
    v_cvt_pk_bf16_f32 v10, v10, v11
    v_cvt_pk_bf16_f32 v12, v12, v13
    v_cvt_pk_bf16_f32 v14, v14, v15
    v_and_b32 v9, 0xffff0000, v8
    v_lshlrev_b32 v8, 16, v8
    v_and_b32 v11, 0xffff0000, v10
    v_lshlrev_b32 v10, 16, v10
    v_and_b32 v13, 0xffff0000, v12
    v_lshlrev_b32 v12, 16, v12
    v_and_b32 v15, 0xffff0000, v14
    v_lshlrev_b32 v14, 16, v14
    v_mul_f32 v8, 1033096506, v8
    v_mul_f32 v9, 1033096506, v9
    v_mul_f32 v10, 1033096506, v10
    v_mul_f32 v11, 1033096506, v11
    v_mul_f32 v12, 1033096506, v12
    v_mul_f32 v13, 1033096506, v13
    v_mul_f32 v14, 1033096506, v14
    v_mul_f32 v15, 1033096506, v15
    v_cvt_pk_bf16_f32 v8, v8, v9
    v_cvt_pk_bf16_f32 v10, v10, v11
    v_cvt_pk_bf16_f32 v12, v12, v13
    v_cvt_pk_bf16_f32 v14, v14, v15
    v_and_b32 v9, 0xffff0000, v8
    v_lshlrev_b32 v8, 16, v8
    v_and_b32 v11, 0xffff0000, v10
    v_lshlrev_b32 v10, 16, v10
    v_and_b32 v13, 0xffff0000, v12
    v_lshlrev_b32 v12, 16, v12
    v_and_b32 v15, 0xffff0000, v14
    v_lshlrev_b32 v14, 16, v14
    s_waitcnt vmcnt(3)
    s_waitcnt lgkmcnt(0)
    v_readfirstlane_b32 s90, v0
    s_cmp_lt_i32 s90, 324
    s_cbranch_scc0 L_go38
    s_waitcnt vmcnt(2)
    s_cmp_lt_i32 s90, 307
    s_cbranch_scc0 L_go38
    s_waitcnt vmcnt(1)
L_go38:
    buffer_load_dwordx4 v[108:111], v2, s[32:35], s86 offen offset:128 nt
    s_mov_b64 exec, 1
    ds_add_rtn_u32 v0, v166, v166 offset:28803
    s_mov_b64 exec, -1
    s_waitcnt vmcnt(3)
    s_waitcnt lgkmcnt(0)
    v_readfirstlane_b32 s90, v0
    s_cmp_lt_i32 s90, 332
    s_cbranch_scc0 L_go39
    s_waitcnt vmcnt(2)
    s_cmp_lt_i32 s90, 315
    s_cbranch_scc0 L_go39
    s_waitcnt vmcnt(1)
L_go39:
    buffer_load_dwordx4 v[112:115], v2, s[32:35], s86 offen offset:256 nt
    s_mov_b64 exec, 1
    ds_add_rtn_u32 v0, v166, v166 offset:28803
    s_mov_b64 exec, -1
    s_waitcnt vmcnt(3)
    s_waitcnt lgkmcnt(0)
    v_readfirstlane_b32 s90, v0
    s_cmp_lt_i32 s90, 340
    s_cbranch_scc0 L_go40
    s_waitcnt vmcnt(2)
    s_cmp_lt_i32 s90, 323
    s_cbranch_scc0 L_go40
    s_waitcnt vmcnt(1)
L_go40:
    s_add_u32 s85, s88, 6
    s_and_b32 s85, s85, 7
    s_mul_i32 s86, s85, 196608
    s_add_u32 s86, s86, 50331648
    buffer_load_dwordx4 v[116:119], v2, s[32:35], s86 offen offset:0 nt
    s_mov_b64 exec, 1
    ds_add_rtn_u32 v0, v166, v166 offset:28803
    s_mov_b64 exec, -1
    v_dot2_f32_bf16 v20, v92, v24, 0
    v_dot2_f32_bf16 v20, v93, v25, v20
    v_dot2_f32_bf16 v20, v94, v26, v20
    v_dot2_f32_bf16 v20, v95, v27, v20
    v_dot2_f32_bf16 v20, v96, v28, v20
    v_dot2_f32_bf16 v20, v97, v29, v20
    v_dot2_f32_bf16 v20, v98, v30, v20
    v_dot2_f32_bf16 v20, v99, v31, v20
    v_dot2_f32_bf16 v20, v100, v32, v20
    v_dot2_f32_bf16 v20, v101, v33, v20
    v_dot2_f32_bf16 v20, v102, v34, v20
    v_dot2_f32_bf16 v20, v103, v35, v20
    v_max3_f32 v62, v8, v9, v10
    v_max3_f32 v62, v62, v11, v12
    v_max3_f32 v62, v62, v13, v14
    v_max_f32 v62, v62, v15
    s_nop 1
    v_max_f32_dpp v62, v62, v62 row_ror:8 row_mask:0xf bank_mask:0xf
    v_mov_b32 v63, v62
    s_nop 1
    v_permlane16_swap_b32 v62, v63
    v_max_f32 v62, v62, v63
    v_mov_b32 v63, v62
    s_nop 1
    v_permlane32_swap_b32 v62, v63
    v_max_f32 v62, v62, v63
    v_mul_f32 v60, s91, v62
    v_fma_f32 v8, v8, s91, -v60
    v_fma_f32 v9, v9, s91, -v60
    v_fma_f32 v10, v10, s91, -v60
    v_fma_f32 v11, v11, s91, -v60
    v_fma_f32 v12, v12, s91, -v60
    v_fma_f32 v13, v13, s91, -v60
    v_fma_f32 v14, v14, s91, -v60
    v_fma_f32 v15, v15, s91, -v60
    v_exp_f32 v8, v8
    v_exp_f32 v9, v9
    v_exp_f32 v10, v10
    v_exp_f32 v11, v11
    v_exp_f32 v12, v12
    v_exp_f32 v13, v13
    v_exp_f32 v14, v14
    v_exp_f32 v15, v15
    s_lshl_b32 s82, s3, 2
    v_mov_b32 v62, s82
    ds_write_b32 v62, v60 offset:28816
    s_waitcnt vmcnt(3)
    s_waitcnt lgkmcnt(0)
    v_readfirstlane_b32 s90, v0
    s_cmp_lt_i32 s90, 348
    s_cbranch_scc0 L_go41
    s_waitcnt vmcnt(2)
    s_cmp_lt_i32 s90, 331
    s_cbranch_scc0 L_go41
    s_waitcnt vmcnt(1)
L_go41:
    buffer_load_dwordx4 v[120:123], v2, s[32:35], s86 offen offset:128 nt
    s_mov_b64 exec, 1
    ds_add_rtn_u32 v0, v166, v166 offset:28803
    s_mov_b64 exec, -1
    s_waitcnt vmcnt(3)
    s_waitcnt lgkmcnt(0)
    v_readfirstlane_b32 s90, v0
    s_cmp_lt_i32 s90, 356
    s_cbranch_scc0 L_go42
    s_waitcnt vmcnt(2)
    s_cmp_lt_i32 s90, 339
    s_cbranch_scc0 L_go42
    s_waitcnt vmcnt(1)
L_go42:
    buffer_load_dwordx4 v[124:127], v2, s[32:35], s86 offen offset:256 nt
    s_mov_b64 exec, 1
    ds_add_rtn_u32 v0, v166, v166 offset:28803
    s_mov_b64 exec, -1
    s_waitcnt vmcnt(3)
    s_waitcnt lgkmcnt(0)
    v_readfirstlane_b32 s90, v0
    s_cmp_lt_i32 s90, 364
    s_cbranch_scc0 L_go43
    s_waitcnt vmcnt(2)
    s_cmp_lt_i32 s90, 347
    s_cbranch_scc0 L_go43
    s_waitcnt vmcnt(1)
L_go43:
    s_add_u32 s85, s88, 7
    s_and_b32 s85, s85, 7
    s_mul_i32 s86, s85, 196608
    s_add_u32 s86, s86, 50331648
    buffer_load_dwordx4 v[128:131], v2, s[32:35], s86 offen offset:0 nt
    s_mov_b64 exec, 1
    ds_add_rtn_u32 v0, v166, v166 offset:28803
    s_mov_b64 exec, -1
    v_dot2_f32_bf16 v21, v104, v24, 0
    v_dot2_f32_bf16 v21, v105, v25, v21
    v_dot2_f32_bf16 v21, v106, v26, v21
    v_dot2_f32_bf16 v21, v107, v27, v21
    v_dot2_f32_bf16 v21, v108, v28, v21
    v_dot2_f32_bf16 v21, v109, v29, v21
    v_dot2_f32_bf16 v21, v110, v30, v21
    v_dot2_f32_bf16 v21, v111, v31, v21
    v_dot2_f32_bf16 v21, v112, v32, v21
    v_dot2_f32_bf16 v21, v113, v33, v21
    v_dot2_f32_bf16 v21, v114, v34, v21
    v_dot2_f32_bf16 v21, v115, v35, v21
    v_add_f32 v64, v8, v9
    v_add_f32 v64, v64, v10
    v_add_f32 v64, v64, v11
    v_add_f32 v64, v64, v12
    v_add_f32 v64, v64, v13
    v_add_f32 v64, v64, v14
    v_add_f32 v64, v64, v15
    v_cvt_pk_bf16_f32 v8, v8, v8
    v_cvt_pk_bf16_f32 v9, v9, v9
    v_cvt_pk_bf16_f32 v10, v10, v10
    v_cvt_pk_bf16_f32 v11, v11, v11
    v_cvt_pk_bf16_f32 v12, v12, v12
    v_cvt_pk_bf16_f32 v13, v13, v13
    v_cvt_pk_bf16_f32 v14, v14, v14
    v_cvt_pk_bf16_f32 v15, v15, v15
    v_add_f32_dpp v64, v64, v64 row_ror:8 row_mask:0xf bank_mask:0xf
    v_mov_b32 v63, v64
    s_nop 1
    v_permlane16_swap_b32 v64, v63
    v_add_f32 v64, v64, v63
    v_mov_b32 v63, v64
    s_nop 1
    v_permlane32_swap_b32 v64, v63
    v_add_f32 v64, v64, v63
    v_writelane_b32 v64, 0, 40
    v_mov_b32 v65, v64
    v_mov_b32 v66, v64
    v_mov_b32 v67, v64
    s_mov_b32 exec_lo, 1
    s_mov_b32 exec_hi, 0x100
    ds_write_b128 v48, v[64:67] offset:768
    s_mov_b64 exec, -1
    s_waitcnt vmcnt(3)
    s_waitcnt lgkmcnt(0)
    v_readfirstlane_b32 s90, v0
    s_cmp_lt_i32 s90, 372
    s_cbranch_scc0 L_go44
    s_waitcnt vmcnt(2)
    s_cmp_lt_i32 s90, 355
    s_cbranch_scc0 L_go44
    s_waitcnt vmcnt(1)
L_go44:
    buffer_load_dwordx4 v[132:135], v2, s[32:35], s86 offen offset:128 nt
    s_mov_b64 exec, 1
    ds_add_rtn_u32 v0, v166, v166 offset:28803
    s_mov_b64 exec, -1
    s_waitcnt vmcnt(3)
    s_waitcnt lgkmcnt(0)
    v_readfirstlane_b32 s90, v0
    s_cmp_lt_i32 s90, 380
    s_cbranch_scc0 L_go45
    s_waitcnt vmcnt(2)
    s_cmp_lt_i32 s90, 363
    s_cbranch_scc0 L_go45
    s_waitcnt vmcnt(1)
L_go45:
    buffer_load_dwordx4 v[136:139], v2, s[32:35], s86 offen offset:256 nt
    s_mov_b64 exec, 1
    ds_add_rtn_u32 v0, v166, v166 offset:28803
    s_mov_b64 exec, -1
    s_waitcnt vmcnt(3)
    s_waitcnt lgkmcnt(0)
    v_readfirstlane_b32 s90, v0
    s_cmp_lt_i32 s90, 388
    s_cbranch_scc0 L_go46
    s_waitcnt vmcnt(2)
    s_cmp_lt_i32 s90, 371
    s_cbranch_scc0 L_go46
    s_waitcnt vmcnt(1)
L_go46:
    s_add_u32 s85, s88, 0
    s_and_b32 s85, s85, 7
    s_mul_i32 s86, s85, 196608
    buffer_load_dwordx4 v[140:143], v2, s[36:39], s86 offen offset:0 nt
    s_mov_b64 exec, 1
    ds_add_rtn_u32 v0, v166, v166 offset:28803
    s_mov_b64 exec, -1
    v_dot2_f32_bf16 v22, v116, v24, 0
    v_dot2_f32_bf16 v22, v117, v25, v22
    v_dot2_f32_bf16 v22, v118, v26, v22
    v_dot2_f32_bf16 v22, v119, v27, v22
    v_dot2_f32_bf16 v22, v120, v28, v22
    v_dot2_f32_bf16 v22, v121, v29, v22
    v_dot2_f32_bf16 v22, v122, v30, v22
    v_dot2_f32_bf16 v22, v123, v31, v22
    v_dot2_f32_bf16 v22, v124, v32, v22
    v_dot2_f32_bf16 v22, v125, v33, v22
    v_dot2_f32_bf16 v22, v126, v34, v22
    v_dot2_f32_bf16 v22, v127, v35, v22
    s_waitcnt vmcnt(3)
    s_waitcnt lgkmcnt(0)
    v_readfirstlane_b32 s90, v0
    s_cmp_lt_i32 s90, 396
    s_cbranch_scc0 L_go47
    s_waitcnt vmcnt(2)
    s_cmp_lt_i32 s90, 379
    s_cbranch_scc0 L_go47
    s_waitcnt vmcnt(1)
L_go47:
    buffer_load_dwordx4 v[144:147], v2, s[36:39], s86 offen offset:128 nt
    s_mov_b64 exec, 1
    ds_add_rtn_u32 v0, v166, v166 offset:28803
    s_mov_b64 exec, -1
    s_waitcnt vmcnt(3)
    s_waitcnt lgkmcnt(0)
    v_readfirstlane_b32 s90, v0
    s_cmp_lt_i32 s90, 404
    s_cbranch_scc0 L_go48
    s_waitcnt vmcnt(2)
    s_cmp_lt_i32 s90, 387
    s_cbranch_scc0 L_go48
    s_waitcnt vmcnt(1)
L_go48:
    buffer_load_dwordx4 v[148:151], v2, s[36:39], s86 offen offset:256 nt
    s_mov_b64 exec, 1
    ds_add_rtn_u32 v0, v166, v166 offset:28803
    s_mov_b64 exec, -1
    s_waitcnt vmcnt(3)
    s_waitcnt lgkmcnt(0)
    v_readfirstlane_b32 s90, v0
    s_cmp_lt_i32 s90, 412
    s_cbranch_scc0 L_go49
    s_waitcnt vmcnt(2)
    s_cmp_lt_i32 s90, 395
    s_cbranch_scc0 L_go49
    s_waitcnt vmcnt(1)
L_go49:
    s_add_u32 s85, s88, 1
    s_and_b32 s85, s85, 7
    s_mul_i32 s86, s85, 196608
    buffer_load_dwordx4 v[152:155], v2, s[36:39], s86 offen offset:0 nt
    s_mov_b64 exec, 1
    ds_add_rtn_u32 v0, v166, v166 offset:28803
    s_mov_b64 exec, -1
    v_dot2_f32_bf16 v23, v128, v24, 0
    v_dot2_f32_bf16 v23, v129, v25, v23
    v_dot2_f32_bf16 v23, v130, v26, v23
    v_dot2_f32_bf16 v23, v131, v27, v23
    v_dot2_f32_bf16 v23, v132, v28, v23
    v_dot2_f32_bf16 v23, v133, v29, v23
    v_dot2_f32_bf16 v23, v134, v30, v23
    v_dot2_f32_bf16 v23, v135, v31, v23
    v_dot2_f32_bf16 v23, v136, v32, v23
    v_dot2_f32_bf16 v23, v137, v33, v23
    v_dot2_f32_bf16 v23, v138, v34, v23
    v_dot2_f32_bf16 v23, v139, v35, v23
    s_waitcnt vmcnt(3)
    s_waitcnt lgkmcnt(0)
    v_readfirstlane_b32 s90, v0
    s_cmp_lt_i32 s90, 420
    s_cbranch_scc0 L_go50
    s_waitcnt vmcnt(2)
    s_cmp_lt_i32 s90, 403
    s_cbranch_scc0 L_go50
    s_waitcnt vmcnt(1)
L_go50:
    buffer_load_dwordx4 v[156:159], v2, s[36:39], s86 offen offset:128 nt
    s_mov_b64 exec, 1
    ds_add_rtn_u32 v0, v166, v166 offset:28803
    s_mov_b64 exec, -1
    s_waitcnt vmcnt(3)
    s_waitcnt lgkmcnt(0)
    v_readfirstlane_b32 s90, v0
    s_cmp_lt_i32 s90, 428
    s_cbranch_scc0 L_go51
    s_waitcnt vmcnt(2)
    s_cmp_lt_i32 s90, 411
    s_cbranch_scc0 L_go51
    s_waitcnt vmcnt(1)
L_go51:
    buffer_load_dwordx4 v[160:163], v2, s[36:39], s86 offen offset:256 nt
    s_mov_b64 exec, 1
    ds_add_rtn_u32 v0, v166, v166 offset:28803
    s_mov_b64 exec, -1
    s_waitcnt vmcnt(3)
    s_waitcnt lgkmcnt(0)
    v_readfirstlane_b32 s90, v0
    s_cmp_lt_i32 s90, 436
    s_cbranch_scc0 L_go52
    s_waitcnt vmcnt(2)
    s_cmp_lt_i32 s90, 419
    s_cbranch_scc0 L_go52
    s_waitcnt vmcnt(1)
L_go52:
    s_add_u32 s85, s88, 2
    s_and_b32 s85, s85, 7
    s_mul_i32 s86, s85, 196608
    buffer_load_dwordx4 v[76:79], v2, s[36:39], s86 offen offset:0 nt
    s_mov_b64 exec, 1
    ds_add_rtn_u32 v0, v166, v166 offset:28803
    s_mov_b64 exec, -1
    v_and_b32 v40, v8, v36
    v_and_b32 v41, v8, v37
    v_and_b32 v42, v8, v38
    v_and_b32 v43, v8, v39
    s_nop 1
    v_mfma_f32_16x16x32_bf16 v[24:27], v[40:43], v[140:143], 0
    v_mfma_f32_16x16x32_bf16 v[28:31], v[40:43], v[144:147], 0
    v_mfma_f32_16x16x32_bf16 v[32:35], v[40:43], v[148:151], 0
    v_add_f32_dpp v16, v16, v16 quad_perm:[1,0,3,2] row_mask:0xf bank_mask:0xf
    v_add_f32_dpp v17, v17, v17 quad_perm:[1,0,3,2] row_mask:0xf bank_mask:0xf
    v_add_f32_dpp v18, v18, v18 quad_perm:[1,0,3,2] row_mask:0xf bank_mask:0xf
    v_add_f32_dpp v19, v19, v19 quad_perm:[1,0,3,2] row_mask:0xf bank_mask:0xf
    v_add_f32_dpp v20, v20, v20 quad_perm:[1,0,3,2] row_mask:0xf bank_mask:0xf
    v_add_f32_dpp v21, v21, v21 quad_perm:[1,0,3,2] row_mask:0xf bank_mask:0xf
    v_add_f32_dpp v22, v22, v22 quad_perm:[1,0,3,2] row_mask:0xf bank_mask:0xf
    v_add_f32_dpp v23, v23, v23 quad_perm:[1,0,3,2] row_mask:0xf bank_mask:0xf
    v_add_f32_dpp v16, v16, v16 quad_perm:[2,3,0,1] row_mask:0xf bank_mask:0xf
    v_add_f32_dpp v17, v17, v17 quad_perm:[2,3,0,1] row_mask:0xf bank_mask:0xf
    v_add_f32_dpp v18, v18, v18 quad_perm:[2,3,0,1] row_mask:0xf bank_mask:0xf
    v_add_f32_dpp v19, v19, v19 quad_perm:[2,3,0,1] row_mask:0xf bank_mask:0xf
    v_add_f32_dpp v20, v20, v20 quad_perm:[2,3,0,1] row_mask:0xf bank_mask:0xf
    v_add_f32_dpp v21, v21, v21 quad_perm:[2,3,0,1] row_mask:0xf bank_mask:0xf
    v_add_f32_dpp v22, v22, v22 quad_perm:[2,3,0,1] row_mask:0xf bank_mask:0xf
    v_add_f32_dpp v23, v23, v23 quad_perm:[2,3,0,1] row_mask:0xf bank_mask:0xf
    v_add_f32_dpp v16, v16, v16 row_half_mirror row_mask:0xf bank_mask:0xf
    v_add_f32_dpp v17, v17, v17 row_half_mirror row_mask:0xf bank_mask:0xf
    v_add_f32_dpp v18, v18, v18 row_half_mirror row_mask:0xf bank_mask:0xf
    v_add_f32_dpp v19, v19, v19 row_half_mirror row_mask:0xf bank_mask:0xf
    v_add_f32_dpp v20, v20, v20 row_half_mirror row_mask:0xf bank_mask:0xf
    v_add_f32_dpp v21, v21, v21 row_half_mirror row_mask:0xf bank_mask:0xf
    v_add_f32_dpp v22, v22, v22 row_half_mirror row_mask:0xf bank_mask:0xf
    v_add_f32_dpp v23, v23, v23 row_half_mirror row_mask:0xf bank_mask:0xf
    s_waitcnt vmcnt(3)
    s_waitcnt lgkmcnt(0)
    v_readfirstlane_b32 s90, v0
    s_cmp_lt_i32 s90, 444
    s_cbranch_scc0 L_go53
    s_waitcnt vmcnt(2)
    s_cmp_lt_i32 s90, 427
    s_cbranch_scc0 L_go53
    s_waitcnt vmcnt(1)
L_go53:
    buffer_load_dwordx4 v[80:83], v2, s[36:39], s86 offen offset:128 nt
    s_mov_b64 exec, 1
    ds_add_rtn_u32 v0, v166, v166 offset:28803
    s_mov_b64 exec, -1
    s_waitcnt vmcnt(3)
    s_waitcnt lgkmcnt(0)
    v_readfirstlane_b32 s90, v0
    s_cmp_lt_i32 s90, 452
    s_cbranch_scc0 L_go54
    s_waitcnt vmcnt(2)
    s_cmp_lt_i32 s90, 435
    s_cbranch_scc0 L_go54
    s_waitcnt vmcnt(1)
L_go54:
    buffer_load_dwordx4 v[84:87], v2, s[36:39], s86 offen offset:256 nt
    s_mov_b64 exec, 1
    ds_add_rtn_u32 v0, v166, v166 offset:28803
    s_mov_b64 exec, -1
    s_waitcnt vmcnt(3)
    s_waitcnt lgkmcnt(0)
    v_readfirstlane_b32 s90, v0
    s_cmp_lt_i32 s90, 460
    s_cbranch_scc0 L_go55
    s_waitcnt vmcnt(2)
    s_cmp_lt_i32 s90, 443
    s_cbranch_scc0 L_go55
    s_waitcnt vmcnt(1)
L_go55:
    s_add_u32 s85, s88, 3
    s_and_b32 s85, s85, 7
    s_mul_i32 s86, s85, 196608
    buffer_load_dwordx4 v[88:91], v2, s[36:39], s86 offen offset:0 nt
    s_mov_b64 exec, 1
    ds_add_rtn_u32 v0, v166, v166 offset:28803
    s_mov_b64 exec, -1
    v_and_b32 v44, v9, v36
    v_and_b32 v45, v9, v37
    v_and_b32 v46, v9, v38
    v_and_b32 v47, v9, v39
    s_nop 1
    v_mfma_f32_16x16x32_bf16 v[24:27], v[44:47], v[152:155], v[24:27]
    v_mfma_f32_16x16x32_bf16 v[28:31], v[44:47], v[156:159], v[28:31]
    v_mfma_f32_16x16x32_bf16 v[32:35], v[44:47], v[160:163], v[32:35]
    v_cvt_pk_bf16_f32 v16, v16, v17
    v_cvt_pk_bf16_f32 v18, v18, v19
    v_cvt_pk_bf16_f32 v20, v20, v21
    v_cvt_pk_bf16_f32 v22, v22, v23
    v_and_b32 v17, 0xffff0000, v16
    v_lshlrev_b32 v16, 16, v16
    v_and_b32 v19, 0xffff0000, v18
    v_lshlrev_b32 v18, 16, v18
    v_and_b32 v21, 0xffff0000, v20
    v_lshlrev_b32 v20, 16, v20
    v_and_b32 v23, 0xffff0000, v22
    v_lshlrev_b32 v22, 16, v22
    v_mul_f32 v16, 1033096506, v16
    v_mul_f32 v17, 1033096506, v17
    v_mul_f32 v18, 1033096506, v18
    v_mul_f32 v19, 1033096506, v19
    v_mul_f32 v20, 1033096506, v20
    v_mul_f32 v21, 1033096506, v21
    v_mul_f32 v22, 1033096506, v22
    v_mul_f32 v23, 1033096506, v23
    v_cvt_pk_bf16_f32 v16, v16, v17
    v_cvt_pk_bf16_f32 v18, v18, v19
    v_cvt_pk_bf16_f32 v20, v20, v21
    v_cvt_pk_bf16_f32 v22, v22, v23
    v_and_b32 v17, 0xffff0000, v16
    v_lshlrev_b32 v16, 16, v16
    v_and_b32 v19, 0xffff0000, v18
    v_lshlrev_b32 v18, 16, v18
    v_and_b32 v21, 0xffff0000, v20
    v_lshlrev_b32 v20, 16, v20
    v_and_b32 v23, 0xffff0000, v22
    v_lshlrev_b32 v22, 16, v22
    s_waitcnt vmcnt(3)
    s_waitcnt lgkmcnt(0)
    v_readfirstlane_b32 s90, v0
    s_cmp_lt_i32 s90, 468
    s_cbranch_scc0 L_go56
    s_waitcnt vmcnt(2)
    s_cmp_lt_i32 s90, 451
    s_cbranch_scc0 L_go56
    s_waitcnt vmcnt(1)
L_go56:
    buffer_load_dwordx4 v[92:95], v2, s[36:39], s86 offen offset:128 nt
    s_mov_b64 exec, 1
    ds_add_rtn_u32 v0, v166, v166 offset:28803
    s_mov_b64 exec, -1
    s_waitcnt vmcnt(3)
    s_waitcnt lgkmcnt(0)
    v_readfirstlane_b32 s90, v0
    s_cmp_lt_i32 s90, 476
    s_cbranch_scc0 L_go57
    s_waitcnt vmcnt(2)
    s_cmp_lt_i32 s90, 459
    s_cbranch_scc0 L_go57
    s_waitcnt vmcnt(1)
L_go57:
    buffer_load_dwordx4 v[96:99], v2, s[36:39], s86 offen offset:256 nt
    s_mov_b64 exec, 1
    ds_add_rtn_u32 v0, v166, v166 offset:28803
    s_mov_b64 exec, -1
    s_waitcnt vmcnt(3)
    s_waitcnt lgkmcnt(0)
    v_readfirstlane_b32 s90, v0
    s_cmp_lt_i32 s90, 484
    s_cbranch_scc0 L_go58
    s_waitcnt vmcnt(2)
    s_cmp_lt_i32 s90, 467
    s_cbranch_scc0 L_go58
    s_waitcnt vmcnt(1)
L_go58:
    s_add_u32 s85, s88, 4
    s_and_b32 s85, s85, 7
    s_mul_i32 s86, s85, 196608
    buffer_load_dwordx4 v[100:103], v2, s[36:39], s86 offen offset:0 nt
    s_mov_b64 exec, 1
    ds_add_rtn_u32 v0, v166, v166 offset:28803
    s_mov_b64 exec, -1
    v_and_b32 v40, v10, v36
    v_and_b32 v41, v10, v37
    v_and_b32 v42, v10, v38
    v_and_b32 v43, v10, v39
    s_nop 1
    v_mfma_f32_16x16x32_bf16 v[24:27], v[40:43], v[76:79], v[24:27]
    v_mfma_f32_16x16x32_bf16 v[28:31], v[40:43], v[80:83], v[28:31]
    v_mfma_f32_16x16x32_bf16 v[32:35], v[40:43], v[84:87], v[32:35]
    v_max3_f32 v62, v16, v17, v18
    v_max3_f32 v62, v62, v19, v20
    v_max3_f32 v62, v62, v21, v22
    v_max_f32 v62, v62, v23
    s_nop 1
    v_max_f32_dpp v62, v62, v62 row_ror:8 row_mask:0xf bank_mask:0xf
    v_mov_b32 v63, v62
    s_nop 1
    v_permlane16_swap_b32 v62, v63
    v_max_f32 v62, v62, v63
    v_mov_b32 v63, v62
    s_nop 1
    v_permlane32_swap_b32 v62, v63
    v_max_f32 v62, v62, v63
    v_mul_f32 v60, s91, v62
    v_fma_f32 v16, v16, s91, -v60
    v_fma_f32 v17, v17, s91, -v60
    v_fma_f32 v18, v18, s91, -v60
    v_fma_f32 v19, v19, s91, -v60
    v_fma_f32 v20, v20, s91, -v60
    v_fma_f32 v21, v21, s91, -v60
    v_fma_f32 v22, v22, s91, -v60
    v_fma_f32 v23, v23, s91, -v60
    v_exp_f32 v16, v16
    v_exp_f32 v17, v17
    v_exp_f32 v18, v18
    v_exp_f32 v19, v19
    v_exp_f32 v20, v20
    v_exp_f32 v21, v21
    v_exp_f32 v22, v22
    v_exp_f32 v23, v23
    s_lshl_b32 s82, s3, 2
    v_mov_b32 v62, s82
    ds_write_b32 v62, v60 offset:28848
    s_waitcnt vmcnt(3)
    s_waitcnt lgkmcnt(0)
    v_readfirstlane_b32 s90, v0
    s_cmp_lt_i32 s90, 492
    s_cbranch_scc0 L_go59
    s_waitcnt vmcnt(2)
    s_cmp_lt_i32 s90, 475
    s_cbranch_scc0 L_go59
    s_waitcnt vmcnt(1)
L_go59:
    buffer_load_dwordx4 v[104:107], v2, s[36:39], s86 offen offset:128 nt
    s_mov_b64 exec, 1
    ds_add_rtn_u32 v0, v166, v166 offset:28803
    s_mov_b64 exec, -1
    s_waitcnt vmcnt(3)
    s_waitcnt lgkmcnt(0)
    v_readfirstlane_b32 s90, v0
    s_cmp_lt_i32 s90, 500
    s_cbranch_scc0 L_go60
    s_waitcnt vmcnt(2)
    s_cmp_lt_i32 s90, 483
    s_cbranch_scc0 L_go60
    s_waitcnt vmcnt(1)
L_go60:
    buffer_load_dwordx4 v[108:111], v2, s[36:39], s86 offen offset:256 nt
    s_mov_b64 exec, 1
    ds_add_rtn_u32 v0, v166, v166 offset:28803
    s_mov_b64 exec, -1
    s_waitcnt vmcnt(3)
    s_waitcnt lgkmcnt(0)
    v_readfirstlane_b32 s90, v0
    s_cmp_lt_i32 s90, 508
    s_cbranch_scc0 L_go61
    s_waitcnt vmcnt(2)
    s_cmp_lt_i32 s90, 491
    s_cbranch_scc0 L_go61
    s_waitcnt vmcnt(1)
L_go61:
    s_add_u32 s85, s88, 5
    s_and_b32 s85, s85, 7
    s_mul_i32 s86, s85, 196608
    buffer_load_dwordx4 v[112:115], v2, s[36:39], s86 offen offset:0 nt
    s_mov_b64 exec, 1
    ds_add_rtn_u32 v0, v166, v166 offset:28803
    s_mov_b64 exec, -1
    v_and_b32 v44, v11, v36
    v_and_b32 v45, v11, v37
    v_and_b32 v46, v11, v38
    v_and_b32 v47, v11, v39
    s_nop 1
    v_mfma_f32_16x16x32_bf16 v[24:27], v[44:47], v[88:91], v[24:27]
    v_mfma_f32_16x16x32_bf16 v[28:31], v[44:47], v[92:95], v[28:31]
    v_mfma_f32_16x16x32_bf16 v[32:35], v[44:47], v[96:99], v[32:35]
    v_add_f32 v64, v16, v17
    v_add_f32 v64, v64, v18
    v_add_f32 v64, v64, v19
    v_add_f32 v64, v64, v20
    v_add_f32 v64, v64, v21
    v_add_f32 v64, v64, v22
    v_add_f32 v64, v64, v23
    v_cvt_pk_bf16_f32 v16, v16, v16
    v_cvt_pk_bf16_f32 v17, v17, v17
    v_cvt_pk_bf16_f32 v18, v18, v18
    v_cvt_pk_bf16_f32 v19, v19, v19
    v_cvt_pk_bf16_f32 v20, v20, v20
    v_cvt_pk_bf16_f32 v21, v21, v21
    v_add_f32_dpp v64, v64, v64 row_ror:8 row_mask:0xf bank_mask:0xf
    v_mov_b32 v63, v64
    s_nop 1
    v_permlane16_swap_b32 v64, v63
    v_add_f32 v64, v64, v63
    v_mov_b32 v63, v64
    s_nop 1
    v_permlane32_swap_b32 v64, v63
    v_add_f32 v64, v64, v63
    v_writelane_b32 v64, 0, 40
    v_mov_b32 v65, v64
    v_mov_b32 v66, v64
    v_mov_b32 v67, v64
    s_mov_b32 exec_lo, 1
    s_mov_b32 exec_hi, 0x100
    ds_write_b128 v48, v[64:67] offset:14336
    s_mov_b64 exec, -1
    s_waitcnt vmcnt(3)
    s_waitcnt lgkmcnt(0)
    v_readfirstlane_b32 s90, v0
    s_cmp_lt_i32 s90, 516
    s_cbranch_scc0 L_go62
    s_waitcnt vmcnt(2)
    s_cmp_lt_i32 s90, 499
    s_cbranch_scc0 L_go62
    s_waitcnt vmcnt(1)
L_go62:
    buffer_load_dwordx4 v[116:119], v2, s[36:39], s86 offen offset:128 nt
    s_mov_b64 exec, 1
    ds_add_rtn_u32 v0, v166, v166 offset:28803
    s_mov_b64 exec, -1
    s_waitcnt vmcnt(3)
    s_waitcnt lgkmcnt(0)
    v_readfirstlane_b32 s90, v0
    s_cmp_lt_i32 s90, 524
    s_cbranch_scc0 L_go63
    s_waitcnt vmcnt(2)
    s_cmp_lt_i32 s90, 507
    s_cbranch_scc0 L_go63
    s_waitcnt vmcnt(1)
L_go63:
    buffer_load_dwordx4 v[120:123], v2, s[36:39], s86 offen offset:256 nt
    s_mov_b64 exec, 1
    ds_add_rtn_u32 v0, v166, v166 offset:28803
    s_mov_b64 exec, -1
    s_waitcnt vmcnt(3)
    s_waitcnt lgkmcnt(0)
    v_readfirstlane_b32 s90, v0
    s_cmp_lt_i32 s90, 532
    s_cbranch_scc0 L_go64
    s_waitcnt vmcnt(2)
    s_cmp_lt_i32 s90, 515
    s_cbranch_scc0 L_go64
    s_waitcnt vmcnt(1)
L_go64:
    s_add_u32 s85, s88, 6
    s_and_b32 s85, s85, 7
    s_mul_i32 s86, s85, 196608
    buffer_load_dwordx4 v[124:127], v2, s[36:39], s86 offen offset:0 nt
    s_mov_b64 exec, 1
    ds_add_rtn_u32 v0, v166, v166 offset:28803
    s_mov_b64 exec, -1
    v_and_b32 v40, v12, v36
    v_and_b32 v41, v12, v37
    v_and_b32 v42, v12, v38
    v_and_b32 v43, v12, v39
    s_nop 1
    v_mfma_f32_16x16x32_bf16 v[24:27], v[40:43], v[100:103], v[24:27]
    v_mfma_f32_16x16x32_bf16 v[28:31], v[40:43], v[104:107], v[28:31]
    v_mfma_f32_16x16x32_bf16 v[32:35], v[40:43], v[108:111], v[32:35]
    v_lshrrev_b32 v68, 4, v1
    v_mov_b32 v69, 2147483648
    s_mul_i32 s82, s3, 6
    v_add_u32 v70, s82, v6
    v_cmp_gt_u32 vcc, 6, v6
    s_nop 1
    v_cndmask_b32 v70, 48, v70, vcc
    v_lshlrev_b32 v70, 4, v70
    v_mul_u32_u24 v61, 1696, v7
    v_add_u32 v61, v61, v70
    v_add_u32 v70, 13568, v61
    v_cmp_eq_u32 s[80:81], 7, v6
    s_nop 1
    v_cndmask_b32 v61, v61, v70, s[80:81]
    v_add_u32 v70, s82, v7
    v_cmp_gt_u32 vcc, 6, v7
    s_nop 1
    v_cndmask_b32 v70, 48, v70, vcc
    v_lshlrev_b32 v70, 4, v70
    v_mul_u32_u24 v49, 1696, v6
    v_add_u32 v49, v49, v70
    s_lshl_b32 s82, s3, 7
    v_lshl_add_u32 v70, v6, 4, s82
    v_lshlrev_b32 v53, 4, v1
    v_cmp_eq_u32 vcc, 0, v7
    s_nop 1
    v_cndmask_b32 v50, v69, v70, vcc
    v_lshlrev_b32 v71, 11, v6
    v_add3_u32 v51, v71, v5, s82
    v_lshl_add_u32 v71, v68, 5, s82
    v_lshl_add_u32 v71, v7, 2, v71
    v_and_b32 v70, 1, v6
    v_lshlrev_b32 v55, 8, v70
    v_lshl_add_u32 v57, v70, 11, v71
    v_cmp_eq_u32 vcc, 0, v70
    s_nop 1
    v_cndmask_b32 v56, v69, v71, vcc
    s_waitcnt vmcnt(3)
    s_waitcnt lgkmcnt(0)
    v_readfirstlane_b32 s90, v0
    s_cmp_lt_i32 s90, 540
    s_cbranch_scc0 L_go65
    s_waitcnt vmcnt(2)
    s_cmp_lt_i32 s90, 523
    s_cbranch_scc0 L_go65
    s_waitcnt vmcnt(1)
L_go65:
    buffer_load_dwordx4 v[128:131], v2, s[36:39], s86 offen offset:128 nt
    s_mov_b64 exec, 1
    ds_add_rtn_u32 v0, v166, v166 offset:28803
    s_mov_b64 exec, -1
    s_waitcnt vmcnt(3)
    s_waitcnt lgkmcnt(0)
    v_readfirstlane_b32 s90, v0
    s_cmp_lt_i32 s90, 548
    s_cbranch_scc0 L_go66
    s_waitcnt vmcnt(2)
    s_cmp_lt_i32 s90, 531
    s_cbranch_scc0 L_go66
    s_waitcnt vmcnt(1)
L_go66:
    buffer_load_dwordx4 v[132:135], v2, s[36:39], s86 offen offset:256 nt
    s_mov_b64 exec, 1
    ds_add_rtn_u32 v0, v166, v166 offset:28803
    s_mov_b64 exec, -1
    s_waitcnt vmcnt(3)
    s_waitcnt lgkmcnt(0)
    v_readfirstlane_b32 s90, v0
    s_cmp_lt_i32 s90, 556
    s_cbranch_scc0 L_go67
    s_waitcnt vmcnt(2)
    s_cmp_lt_i32 s90, 539
    s_cbranch_scc0 L_go67
    s_waitcnt vmcnt(1)
L_go67:
    s_add_u32 s85, s88, 7
    s_and_b32 s85, s85, 7
    s_mul_i32 s86, s85, 196608
    buffer_load_dwordx4 v[136:139], v2, s[36:39], s86 offen offset:0 nt
    s_mov_b64 exec, 1
    ds_add_rtn_u32 v0, v166, v166 offset:28803
    s_mov_b64 exec, -1
    v_and_b32 v44, v13, v36
    v_and_b32 v45, v13, v37
    v_and_b32 v46, v13, v38
    v_and_b32 v47, v13, v39
    s_nop 1
    v_mfma_f32_16x16x32_bf16 v[24:27], v[44:47], v[112:115], v[24:27]
    v_mfma_f32_16x16x32_bf16 v[28:31], v[44:47], v[116:119], v[28:31]
    v_mfma_f32_16x16x32_bf16 v[32:35], v[44:47], v[120:123], v[32:35]
    s_mul_i32 s82, s3, 24
    v_lshl_add_u32 v55, v68, 3, v55
    v_add_u32 v55, s82, v55
    v_and_b32 v70, 15, v1
    v_lshlrev_b32 v70, 5, v70
    v_lshrrev_b32 v71, 5, v1
    v_mul_u32_u24 v71, 320, v71
    v_and_b32 v72, 1, v68
    v_lshlrev_b32 v72, 4, v72
    v_add3_u32 v52, v70, v71, v72
    s_mul_i32 s82, s3, 640
    v_add_u32 v52, s82, v52
    v_lshlrev_b32 v54, 2, v7
    v_mov_b32 v75, s78
    s_waitcnt vmcnt(3)
    s_waitcnt lgkmcnt(0)
    v_readfirstlane_b32 s90, v0
    s_cmp_lt_i32 s90, 564
    s_cbranch_scc0 L_go68
    s_waitcnt vmcnt(2)
    s_cmp_lt_i32 s90, 547
    s_cbranch_scc0 L_go68
    s_waitcnt vmcnt(1)
L_go68:
    buffer_load_dwordx4 v[140:143], v2, s[36:39], s86 offen offset:128 nt
    s_mov_b64 exec, 1
    ds_add_rtn_u32 v0, v166, v166 offset:28803
    s_mov_b64 exec, -1
    s_waitcnt vmcnt(3)
    s_waitcnt lgkmcnt(0)
    v_readfirstlane_b32 s90, v0
    s_cmp_lt_i32 s90, 572
    s_cbranch_scc0 L_go69
    s_waitcnt vmcnt(2)
    s_cmp_lt_i32 s90, 555
    s_cbranch_scc0 L_go69
    s_waitcnt vmcnt(1)
L_go69:
    buffer_load_dwordx4 v[144:147], v2, s[36:39], s86 offen offset:256 nt
    s_mov_b64 exec, 1
    ds_add_rtn_u32 v0, v166, v166 offset:28803
    s_mov_b64 exec, -1
    s_waitcnt vmcnt(3)
    s_waitcnt lgkmcnt(0)
    v_readfirstlane_b32 s90, v0
    s_cmp_lt_i32 s90, 580
    s_cbranch_scc0 L_go70
    s_waitcnt vmcnt(2)
    s_cmp_lt_i32 s90, 563
    s_cbranch_scc0 L_go70
    s_waitcnt vmcnt(1)
L_go70:
    s_add_u32 s85, s88, 0
    s_and_b32 s85, s85, 7
    s_mul_i32 s86, s85, 196608
    s_add_u32 s86, s86, 50331648
    buffer_load_dwordx4 v[148:151], v2, s[36:39], s86 offen offset:0 nt
    s_mov_b64 exec, 1
    ds_add_rtn_u32 v0, v166, v166 offset:28803
    s_mov_b64 exec, -1
    v_and_b32 v40, v14, v36
    v_and_b32 v41, v14, v37
    v_and_b32 v42, v14, v38
    v_and_b32 v43, v14, v39
    s_nop 1
    v_mfma_f32_16x16x32_bf16 v[24:27], v[40:43], v[124:127], v[24:27]
    v_mfma_f32_16x16x32_bf16 v[28:31], v[40:43], v[128:131], v[28:31]
    v_mfma_f32_16x16x32_bf16 v[32:35], v[40:43], v[132:135], v[32:35]
    s_waitcnt vmcnt(3)
    s_waitcnt lgkmcnt(0)
    v_readfirstlane_b32 s90, v0
    s_cmp_lt_i32 s90, 588
    s_cbranch_scc0 L_go71
    s_waitcnt vmcnt(2)
    s_cmp_lt_i32 s90, 571
    s_cbranch_scc0 L_go71
    s_waitcnt vmcnt(1)
L_go71:
    buffer_load_dwordx4 v[152:155], v2, s[36:39], s86 offen offset:128 nt
    s_mov_b64 exec, 1
    ds_add_rtn_u32 v0, v166, v166 offset:28803
    s_mov_b64 exec, -1
    s_waitcnt vmcnt(3)
    s_waitcnt lgkmcnt(0)
    v_readfirstlane_b32 s90, v0
    s_cmp_lt_i32 s90, 596
    s_cbranch_scc0 L_go72
    s_waitcnt vmcnt(2)
    s_cmp_lt_i32 s90, 579
    s_cbranch_scc0 L_go72
    s_waitcnt vmcnt(1)
L_go72:
    buffer_load_dwordx4 v[156:159], v2, s[36:39], s86 offen offset:256 nt
    s_mov_b64 exec, 1
    ds_add_rtn_u32 v0, v166, v166 offset:28803
    s_mov_b64 exec, -1
    s_waitcnt vmcnt(3)
    s_waitcnt lgkmcnt(0)
    v_readfirstlane_b32 s90, v0
    s_cmp_lt_i32 s90, 604
    s_cbranch_scc0 L_go73
    s_waitcnt vmcnt(2)
    s_cmp_lt_i32 s90, 587
    s_cbranch_scc0 L_go73
    s_waitcnt vmcnt(1)
L_go73:
    s_add_u32 s85, s88, 1
    s_and_b32 s85, s85, 7
    s_mul_i32 s86, s85, 196608
    s_add_u32 s86, s86, 50331648
    buffer_load_dwordx4 v[160:163], v2, s[36:39], s86 offen offset:0 nt
    s_mov_b64 exec, 1
    ds_add_rtn_u32 v0, v166, v166 offset:28803
    s_mov_b64 exec, -1
    v_and_b32 v44, v15, v36
    v_and_b32 v45, v15, v37
    v_and_b32 v46, v15, v38
    v_and_b32 v47, v15, v39
    s_nop 1
    v_mfma_f32_16x16x32_bf16 v[24:27], v[44:47], v[136:139], v[24:27]
    v_mfma_f32_16x16x32_bf16 v[28:31], v[44:47], v[140:143], v[28:31]
    v_mfma_f32_16x16x32_bf16 v[32:35], v[44:47], v[144:147], v[32:35]
    s_mov_b32 exec_lo, 0x00ff00ff
    s_mov_b32 exec_hi, 0xff00ff00
    s_nop 3
    ds_write_b128 v48, v[24:27] offset:0
    ds_write_b128 v48, v[28:31] offset:256
    ds_write_b128 v48, v[32:35] offset:512
    s_mov_b64 exec, 1
    ds_add_u32 v166, v166 offset:28807
    s_mov_b64 exec, -1
    s_waitcnt vmcnt(3)
    s_waitcnt lgkmcnt(0)
    v_readfirstlane_b32 s90, v0
    s_cmp_lt_i32 s90, 612
    s_cbranch_scc0 L_go74
    s_waitcnt vmcnt(2)
    s_cmp_lt_i32 s90, 595
    s_cbranch_scc0 L_go74
    s_waitcnt vmcnt(1)
L_go74:
    buffer_load_dwordx4 v[76:79], v2, s[36:39], s86 offen offset:128 nt
    s_mov_b64 exec, 1
    ds_add_rtn_u32 v0, v166, v166 offset:28803
    s_mov_b64 exec, -1
    s_waitcnt vmcnt(3)
    s_waitcnt lgkmcnt(0)
    v_readfirstlane_b32 s90, v0
    s_cmp_lt_i32 s90, 620
    s_cbranch_scc0 L_go75
    s_waitcnt vmcnt(2)
    s_cmp_lt_i32 s90, 603
    s_cbranch_scc0 L_go75
    s_waitcnt vmcnt(1)
L_go75:
    buffer_load_dwordx4 v[80:83], v2, s[36:39], s86 offen offset:256 nt
    s_mov_b64 exec, 1
    ds_add_rtn_u32 v0, v166, v166 offset:28803
    s_mov_b64 exec, -1
    s_waitcnt vmcnt(3)
    s_waitcnt lgkmcnt(0)
    v_readfirstlane_b32 s90, v0
    s_cmp_lt_i32 s90, 628
    s_cbranch_scc0 L_go76
    s_waitcnt vmcnt(2)
    s_cmp_lt_i32 s90, 611
    s_cbranch_scc0 L_go76
    s_waitcnt vmcnt(1)
L_go76:
    s_add_u32 s85, s88, 2
    s_and_b32 s85, s85, 7
    s_mul_i32 s86, s85, 196608
    s_add_u32 s86, s86, 50331648
    buffer_load_dwordx4 v[84:87], v2, s[36:39], s86 offen offset:0 nt
    s_mov_b64 exec, 1
    ds_add_rtn_u32 v0, v166, v166 offset:28803
    s_mov_b64 exec, -1
    v_and_b32 v40, v16, v36
    v_and_b32 v41, v16, v37
    v_and_b32 v42, v16, v38
    v_and_b32 v43, v16, v39
    s_waitcnt lgkmcnt(0)
    s_nop 0
    v_mfma_f32_16x16x32_bf16 v[24:27], v[40:43], v[148:151], 0
    v_mfma_f32_16x16x32_bf16 v[28:31], v[40:43], v[152:155], 0
    v_mfma_f32_16x16x32_bf16 v[32:35], v[40:43], v[156:159], 0
    s_waitcnt vmcnt(3)
    s_waitcnt lgkmcnt(0)
    v_readfirstlane_b32 s90, v0
    s_cmp_lt_i32 s90, 636
    s_cbranch_scc0 L_go77
    s_waitcnt vmcnt(2)
    s_cmp_lt_i32 s90, 619
    s_cbranch_scc0 L_go77
    s_waitcnt vmcnt(1)
L_go77:
    buffer_load_dwordx4 v[88:91], v2, s[36:39], s86 offen offset:128 nt
    s_mov_b64 exec, 1
    ds_add_rtn_u32 v0, v166, v166 offset:28803
    s_mov_b64 exec, -1
    s_waitcnt vmcnt(3)
    s_waitcnt lgkmcnt(0)
    v_readfirstlane_b32 s90, v0
    s_cmp_lt_i32 s90, 644
    s_cbranch_scc0 L_go78
    s_waitcnt vmcnt(2)
    s_cmp_lt_i32 s90, 627
    s_cbranch_scc0 L_go78
    s_waitcnt vmcnt(1)
L_go78:
    buffer_load_dwordx4 v[92:95], v2, s[36:39], s86 offen offset:256 nt
    s_mov_b64 exec, 1
    ds_add_rtn_u32 v0, v166, v166 offset:28803
    s_mov_b64 exec, -1
    s_waitcnt vmcnt(3)
    s_waitcnt lgkmcnt(0)
    v_readfirstlane_b32 s90, v0
    s_cmp_lt_i32 s90, 652
    s_cbranch_scc0 L_go79
    s_waitcnt vmcnt(2)
    s_cmp_lt_i32 s90, 635
    s_cbranch_scc0 L_go79
    s_waitcnt vmcnt(1)
L_go79:
    s_add_u32 s85, s88, 3
    s_and_b32 s85, s85, 7
    s_mul_i32 s86, s85, 196608
    s_add_u32 s86, s86, 50331648
    buffer_load_dwordx4 v[96:99], v2, s[36:39], s86 offen offset:0 nt
    s_mov_b64 exec, 1
    ds_add_rtn_u32 v0, v166, v166 offset:28803
    s_mov_b64 exec, -1
    v_and_b32 v44, v17, v36
    v_and_b32 v45, v17, v37
    v_and_b32 v46, v17, v38
    v_and_b32 v47, v17, v39
    s_nop 1
    v_mfma_f32_16x16x32_bf16 v[24:27], v[44:47], v[160:163], v[24:27]
    v_mfma_f32_16x16x32_bf16 v[28:31], v[44:47], v[76:79], v[28:31]
    v_mfma_f32_16x16x32_bf16 v[32:35], v[44:47], v[80:83], v[32:35]
L_m1:
    ds_read_b32 v66, v166 offset:28807
    ds_read_b32 v62, v54 offset:28816
    ds_read_b32 v63, v54 offset:28848
    ds_read_b128 v[8:11], v61
    ds_read_b128 v[12:15], v61 offset:848
    ds_read_b64 v[72:73], v55 offset:28160
    ds_read_b32 v58, v166 offset:28671
    ds_read_b32 v59, v166 offset:28735
    s_waitcnt lgkmcnt(0)
    v_readfirstlane_b32 s82, v66
    s_cmp_eq_u32 s82, 9
    s_cbranch_scc1 L_m1d
    s_sleep 1
    s_sub_u32 s92, s92, 1
    s_cbranch_scc0 L_m1
    s_endpgm
L_m1d:
    v_max_f32_dpp v64, v62, v62 quad_perm:[1,0,3,2] row_mask:0xf bank_mask:0xf
    v_max_f32_dpp v65, v63, v63 quad_perm:[1,0,3,2] row_mask:0xf bank_mask:0xf
    v_add_f32 v8, v8, v12
    v_max_f32_dpp v64, v64, v64 quad_perm:[2,3,0,1] row_mask:0xf bank_mask:0xf
    v_max_f32_dpp v65, v65, v65 quad_perm:[2,3,0,1] row_mask:0xf bank_mask:0xf
    v_add_f32 v9, v9, v13
    v_max_f32_dpp v64, v64, v64 row_half_mirror row_mask:0xf bank_mask:0xf
    v_max_f32_dpp v65, v65, v65 row_half_mirror row_mask:0xf bank_mask:0xf
    v_add_f32 v10, v10, v14
    v_add_f32 v11, v11, v15
    v_and_b32 v64, s77, v64
    v_and_b32 v65, s77, v65
    v_sub_f32 v62, v62, v64
    v_sub_f32 v63, v63, v65
    v_cndmask_b32 v62, v62, v63, s[80:81]
    v_exp_f32 v62, v62
    s_nop 0
    v_mul_f32 v8, v8, v62
    v_mul_f32 v9, v9, v62
    v_mul_f32 v10, v10, v62
    v_mul_f32 v11, v11, v62
    v_add_f32_dpp v8, v8, v8 quad_perm:[1,0,3,2] row_mask:0xf bank_mask:0xf
    v_add_f32_dpp v9, v9, v9 quad_perm:[1,0,3,2] row_mask:0xf bank_mask:0xf
    v_add_f32_dpp v10, v10, v10 quad_perm:[1,0,3,2] row_mask:0xf bank_mask:0xf
    v_add_f32_dpp v11, v11, v11 quad_perm:[1,0,3,2] row_mask:0xf bank_mask:0xf
    v_add_f32_dpp v8, v8, v8 quad_perm:[2,3,0,1] row_mask:0xf bank_mask:0xf
    v_add_f32_dpp v9, v9, v9 quad_perm:[2,3,0,1] row_mask:0xf bank_mask:0xf
    v_add_f32_dpp v10, v10, v10 quad_perm:[2,3,0,1] row_mask:0xf bank_mask:0xf
    v_add_f32_dpp v11, v11, v11 quad_perm:[2,3,0,1] row_mask:0xf bank_mask:0xf
    v_add_f32_dpp v8, v8, v8 row_half_mirror row_mask:0xf bank_mask:0xf
    v_add_f32_dpp v9, v9, v9 row_half_mirror row_mask:0xf bank_mask:0xf
    v_add_f32_dpp v10, v10, v10 row_half_mirror row_mask:0xf bank_mask:0xf
    v_add_f32_dpp v11, v11, v11 row_half_mirror row_mask:0xf bank_mask:0xf
    v_cndmask_b32 v8, v8, v64, s[80:81]
    v_cndmask_b32 v9, v9, v65, s[80:81]
    v_and_or_b32 v8, v8, s77, v75
    v_and_or_b32 v9, v9, s77, v75
    v_and_or_b32 v10, v10, s77, v75
    v_and_or_b32 v11, v11, s77, v75
    s_cmp_eq_u32 s89, 1
    s_cbranch_scc1 L_ofast0
    buffer_store_dwordx4 v[8:11], v50, s[68:71], s100 offen sc1
    s_branch L_odone0
L_ofast0:
    buffer_store_dwordx4 v[8:11], v50, s[68:71], s100 offen
L_odone0:
    s_waitcnt vmcnt(4)
    s_waitcnt lgkmcnt(0)
    v_readfirstlane_b32 s90, v0
    s_cmp_lt_i32 s90, 660
    s_cbranch_scc0 L_go80
    s_waitcnt vmcnt(3)
    s_cmp_lt_i32 s90, 643
    s_cbranch_scc0 L_go80
    s_waitcnt vmcnt(2)
L_go80:
    buffer_load_dwordx4 v[100:103], v2, s[36:39], s86 offen offset:128 nt
    s_mov_b64 exec, 1
    ds_add_rtn_u32 v0, v166, v166 offset:28803
    s_mov_b64 exec, -1
    s_waitcnt vmcnt(4)
    s_waitcnt lgkmcnt(0)
    v_readfirstlane_b32 s90, v0
    s_cmp_lt_i32 s90, 668
    s_cbranch_scc0 L_go81
    s_waitcnt vmcnt(3)
    s_cmp_lt_i32 s90, 651
    s_cbranch_scc0 L_go81
    s_waitcnt vmcnt(2)
L_go81:
    buffer_load_dwordx4 v[104:107], v2, s[36:39], s86 offen offset:256 nt
    s_mov_b64 exec, 1
    ds_add_rtn_u32 v0, v166, v166 offset:28803
    s_mov_b64 exec, -1
    s_waitcnt vmcnt(4)
    s_waitcnt lgkmcnt(0)
    v_readfirstlane_b32 s90, v0
    s_cmp_lt_i32 s90, 676
    s_cbranch_scc0 L_go82
    s_waitcnt vmcnt(3)
    s_cmp_lt_i32 s90, 659
    s_cbranch_scc0 L_go82
    s_waitcnt vmcnt(1)
L_go82:
    s_add_u32 s85, s88, 4
    s_and_b32 s85, s85, 7
    s_mul_i32 s86, s85, 196608
    s_add_u32 s86, s86, 50331648
    buffer_load_dwordx4 v[108:111], v2, s[36:39], s86 offen offset:0 nt
    s_mov_b64 exec, 1
    ds_add_rtn_u32 v0, v166, v166 offset:28803
    s_mov_b64 exec, -1
    v_and_b32 v40, v18, v36
    v_and_b32 v41, v18, v37
    v_and_b32 v42, v18, v38
    v_and_b32 v43, v18, v39
    s_nop 1
    v_mfma_f32_16x16x32_bf16 v[24:27], v[40:43], v[84:87], v[24:27]
    v_mfma_f32_16x16x32_bf16 v[28:31], v[40:43], v[88:91], v[28:31]
    v_mfma_f32_16x16x32_bf16 v[32:35], v[40:43], v[92:95], v[32:35]
    s_waitcnt vmcnt(4)
    s_waitcnt lgkmcnt(0)
    v_readfirstlane_b32 s90, v0
    s_cmp_lt_i32 s90, 684
    s_cbranch_scc0 L_go83
    s_waitcnt vmcnt(2)
    s_cmp_lt_i32 s90, 667
    s_cbranch_scc0 L_go83
    s_waitcnt vmcnt(1)
L_go83:
    buffer_load_dwordx4 v[112:115], v2, s[36:39], s86 offen offset:128 nt
    s_mov_b64 exec, 1
    ds_add_rtn_u32 v0, v166, v166 offset:28803
    s_mov_b64 exec, -1
    s_waitcnt vmcnt(3)
    s_waitcnt lgkmcnt(0)
    v_readfirstlane_b32 s90, v0
    s_cmp_lt_i32 s90, 692
    s_cbranch_scc0 L_go84
    s_waitcnt vmcnt(2)
    s_cmp_lt_i32 s90, 675
    s_cbranch_scc0 L_go84
    s_waitcnt vmcnt(1)
L_go84:
    buffer_load_dwordx4 v[116:119], v2, s[36:39], s86 offen offset:256 nt
    s_mov_b64 exec, 1
    ds_add_rtn_u32 v0, v166, v166 offset:28803
    s_mov_b64 exec, -1
    s_waitcnt vmcnt(3)
    s_waitcnt lgkmcnt(0)
    v_readfirstlane_b32 s90, v0
    s_cmp_lt_i32 s90, 700
    s_cbranch_scc0 L_go85
    s_waitcnt vmcnt(2)
    s_cmp_lt_i32 s90, 683
    s_cbranch_scc0 L_go85
    s_waitcnt vmcnt(1)
L_go85:
    s_add_u32 s85, s88, 5
    s_and_b32 s85, s85, 7
    s_mul_i32 s86, s85, 196608
    s_add_u32 s86, s86, 50331648
    buffer_load_dwordx4 v[120:123], v2, s[36:39], s86 offen offset:0 nt
    s_mov_b64 exec, 1
    ds_add_rtn_u32 v0, v166, v166 offset:28803
    s_mov_b64 exec, -1
    v_and_b32 v44, v19, v36
    v_and_b32 v45, v19, v37
    v_and_b32 v46, v19, v38
    v_and_b32 v47, v19, v39
    s_nop 1
    v_mfma_f32_16x16x32_bf16 v[24:27], v[44:47], v[96:99], v[24:27]
    v_mfma_f32_16x16x32_bf16 v[28:31], v[44:47], v[100:103], v[28:31]
    v_mfma_f32_16x16x32_bf16 v[32:35], v[44:47], v[104:107], v[32:35]
    s_waitcnt vmcnt(3)
    s_waitcnt lgkmcnt(0)
    v_readfirstlane_b32 s90, v0
    s_cmp_lt_i32 s90, 708
    s_cbranch_scc0 L_go86
    s_waitcnt vmcnt(2)
    s_cmp_lt_i32 s90, 691
    s_cbranch_scc0 L_go86
    s_waitcnt vmcnt(1)
L_go86:
    buffer_load_dwordx4 v[124:127], v2, s[36:39], s86 offen offset:128 nt
    s_mov_b64 exec, 1
    ds_add_rtn_u32 v0, v166, v166 offset:28803
    s_mov_b64 exec, -1
    s_waitcnt vmcnt(3)
    s_waitcnt lgkmcnt(0)
    v_readfirstlane_b32 s90, v0
    s_cmp_lt_i32 s90, 716
    s_cbranch_scc0 L_go87
    s_waitcnt vmcnt(2)
    s_cmp_lt_i32 s90, 699
    s_cbranch_scc0 L_go87
    s_waitcnt vmcnt(1)
L_go87:
    buffer_load_dwordx4 v[128:131], v2, s[36:39], s86 offen offset:256 nt
    s_mov_b64 exec, 1
    ds_add_rtn_u32 v0, v166, v166 offset:28803
    s_mov_b64 exec, -1
    s_waitcnt vmcnt(3)
    s_waitcnt lgkmcnt(0)
    v_readfirstlane_b32 s90, v0
    s_cmp_lt_i32 s90, 724
    s_cbranch_scc0 L_go88
    s_waitcnt vmcnt(2)
    s_cmp_lt_i32 s90, 707
    s_cbranch_scc0 L_go88
    s_waitcnt vmcnt(1)
L_go88:
    s_add_u32 s85, s88, 6
    s_and_b32 s85, s85, 7
    s_mul_i32 s86, s85, 196608
    s_add_u32 s86, s86, 50331648
    buffer_load_dwordx4 v[132:135], v2, s[36:39], s86 offen offset:0 nt
    s_mov_b64 exec, 1
    ds_add_rtn_u32 v0, v166, v166 offset:28803
    s_mov_b64 exec, -1
    v_and_b32 v40, v20, v36
    v_and_b32 v41, v20, v37
    v_and_b32 v42, v20, v38
    v_and_b32 v43, v20, v39
    s_nop 1
    v_mfma_f32_16x16x32_bf16 v[24:27], v[40:43], v[108:111], v[24:27]
    v_mfma_f32_16x16x32_bf16 v[28:31], v[40:43], v[112:115], v[28:31]
    v_mfma_f32_16x16x32_bf16 v[32:35], v[40:43], v[116:119], v[32:35]
    buffer_load_dwordx4 v[12:15], v51, s[68:71], s93 offen sc1
    s_waitcnt vmcnt(4)
    s_waitcnt lgkmcnt(0)
    v_readfirstlane_b32 s90, v0
    s_cmp_lt_i32 s90, 732
    s_cbranch_scc0 L_go89
    s_waitcnt vmcnt(3)
    s_cmp_lt_i32 s90, 715
    s_cbranch_scc0 L_go89
    s_waitcnt vmcnt(2)
L_go89:
    buffer_load_dwordx4 v[136:139], v2, s[36:39], s86 offen offset:128 nt
    s_mov_b64 exec, 1
    ds_add_rtn_u32 v0, v166, v166 offset:28803
    s_mov_b64 exec, -1
    s_waitcnt vmcnt(4)
    s_waitcnt lgkmcnt(0)
    v_readfirstlane_b32 s90, v0
    s_cmp_lt_i32 s90, 740
    s_cbranch_scc0 L_go90
    s_waitcnt vmcnt(3)
    s_cmp_lt_i32 s90, 723
    s_cbranch_scc0 L_go90
    s_waitcnt vmcnt(2)
L_go90:
    buffer_load_dwordx4 v[140:143], v2, s[36:39], s86 offen offset:256 nt
    s_mov_b64 exec, 1
    ds_add_rtn_u32 v0, v166, v166 offset:28803
    s_mov_b64 exec, -1
    s_waitcnt vmcnt(4)
    s_waitcnt lgkmcnt(0)
    v_readfirstlane_b32 s90, v0
    s_cmp_lt_i32 s90, 748
    s_cbranch_scc0 L_go91
    s_waitcnt vmcnt(3)
    s_cmp_lt_i32 s90, 731
    s_cbranch_scc0 L_go91
    s_waitcnt vmcnt(1)
L_go91:
    s_add_u32 s85, s88, 7
    s_and_b32 s85, s85, 7
    s_mul_i32 s86, s85, 196608
    s_add_u32 s86, s86, 50331648
    buffer_load_dwordx4 v[144:147], v2, s[36:39], s86 offen offset:0 nt
    s_mov_b64 exec, 1
    ds_add_rtn_u32 v0, v166, v166 offset:28803
    s_mov_b64 exec, -1
    v_and_b32 v44, v21, v36
    v_and_b32 v45, v21, v37
    v_and_b32 v46, v21, v38
    v_and_b32 v47, v21, v39
    s_nop 1
    v_mfma_f32_16x16x32_bf16 v[24:27], v[44:47], v[120:123], v[24:27]
    v_mfma_f32_16x16x32_bf16 v[28:31], v[44:47], v[124:127], v[28:31]
    v_mfma_f32_16x16x32_bf16 v[32:35], v[44:47], v[128:131], v[32:35]
    s_waitcnt vmcnt(4)
    s_waitcnt lgkmcnt(0)
    v_readfirstlane_b32 s90, v0
    s_cmp_lt_i32 s90, 756
    s_cbranch_scc0 L_go92
    s_waitcnt vmcnt(2)
    s_cmp_lt_i32 s90, 739
    s_cbranch_scc0 L_go92
    s_waitcnt vmcnt(1)
L_go92:
    buffer_load_dwordx4 v[148:151], v2, s[36:39], s86 offen offset:128 nt
    s_mov_b64 exec, 1
    ds_add_rtn_u32 v0, v166, v166 offset:28803
    s_mov_b64 exec, -1
    buffer_load_dwordx4 v[152:155], v4, s[52:55], 0 offen offset:1280
    s_waitcnt vmcnt(4)
    s_waitcnt lgkmcnt(0)
    v_readfirstlane_b32 s90, v0
    s_cmp_lt_i32 s90, 764
    s_cbranch_scc0 L_go93
    s_waitcnt vmcnt(3)
    s_cmp_lt_i32 s90, 747
    s_cbranch_scc0 L_go93
    s_waitcnt vmcnt(2)
L_go93:
    buffer_load_dwordx4 v[156:159], v2, s[36:39], s86 offen offset:256 nt
    s_mov_b64 exec, 1
    ds_add_rtn_u32 v0, v166, v166 offset:28803
    s_mov_b64 exec, -1
L_m2:
    v_xor_b32 v12, s78, v12
    v_xor_b32 v13, s78, v13
    v_xor_b32 v14, s78, v14
    v_xor_b32 v15, s78, v15
    v_or3_b32 v62, v12, v13, v14
    v_or_b32 v62, v62, v15
    v_and_b32 v62, 1023, v62
    v_cmp_ne_u32 vcc, 0, v62
    s_cbranch_vccz L_m2d
    buffer_load_dwordx4 v[12:15], v51, s[68:71], s93 offen sc1
    s_waitcnt vmcnt(0)
    s_sub_u32 s92, s92, 1
    s_cbranch_scc0 L_m2
    s_endpgm
L_m2d:
    v_mov_b32_dpp v62, v12 row_newbcast:7 row_mask:0xf bank_mask:0x3
    v_mov_b32 v64, v13
    s_nop 0
    v_mov_b32_dpp v62, v12 row_newbcast:15 row_mask:0xf bank_mask:0xc
    v_max_f32_dpp v64, v64, v64 row_ror:8 row_mask:0xf bank_mask:0xf
    v_mov_b32 v66, v64
    s_nop 1
    v_permlane16_swap_b32 v64, v66
    v_max_f32 v64, v64, v66
    v_mov_b32 v66, v64
    s_nop 1
    v_permlane32_swap_b32 v64, v66
    v_max_f32 v64, v64, v66
    v_mov_b32 v63, v62
    s_nop 1
    v_max_f32_dpp v63, v63, v63 row_ror:8 row_mask:0xf bank_mask:0xf
    v_mov_b32 v66, v63
    s_nop 1
    v_permlane16_swap_b32 v63, v66
    v_max_f32 v63, v63, v66
    v_mov_b32 v66, v63
    s_nop 1
    v_permlane32_swap_b32 v63, v66
    v_max_f32 v63, v63, v66
    v_sub_f32 v65, v13, v64
    v_sub_f32 v62, v62, v63
    v_exp_f32 v65, v65
    v_exp_f32 v62, v62
    v_mul_f32 v65, v65, v14
    v_mul_f32 v12, v12, v62
    v_mul_f32 v13, v13, v62
    v_mul_f32 v14, v14, v62
    v_mul_f32 v15, v15, v62
    v_add_f32_dpp v65, v65, v65 row_ror:8 row_mask:0xf bank_mask:0xf
    v_mov_b32 v66, v65
    s_nop 1
    v_permlane16_swap_b32 v65, v66
    v_add_f32 v65, v65, v66
    v_mov_b32 v66, v65
    s_nop 1
    v_permlane32_swap_b32 v65, v66
    v_add_f32 v65, v65, v66
    v_readlane_b32 s82, v64, 7
    v_rcp_f32 v65, v65
    v_permlane16_swap_b32 v12, v13
    v_permlane16_swap_b32 v14, v15
    v_readlane_b32 s83, v65, 7
    v_add_f32 v12, v12, v13
    v_add_f32 v14, v14, v15
    v_subrev_f32 v64, s82, v60
    s_nop 0
    v_permlane32_swap_b32 v12, v14
    v_exp_f32 v64, v64
    v_add_f32 v12, v12, v14
    v_mul_f32 v59, s83, v59
    v_mul_f32 v59, v59, v64
    v_add_f32_dpp v12, v12, v12 row_ror:8 row_mask:0xf bank_mask:0xf
    v_rcp_f32 v63, v12
    v_mul_f32 v12, v12, v58
    v_mul_f32 v22, v22, v59
    v_mul_f32 v23, v23, v59
    v_mul_f32_dpp v12, v63, v12 row_newbcast:6 row_mask:0xf bank_mask:0xf
    v_cvt_pk_bf16_f32 v22, v22, v22
    v_cvt_pk_bf16_f32 v23, v23, v23
    v_cvt_pk_bf16_f32 v12, v12, v12
    v_mul_f32 v24, v24, v59
    v_mul_f32 v25, v25, v59
    v_mul_f32 v26, v26, v59
    v_mul_f32 v27, v27, v59
    v_mul_f32 v28, v28, v59
    v_mul_f32 v29, v29, v59
    v_mul_f32 v30, v30, v59
    v_mul_f32 v31, v31, v59
    v_mul_f32 v32, v32, v59
    v_mul_f32 v33, v33, v59
    v_mul_f32 v34, v34, v59
    v_mul_f32 v35, v35, v59
    v_and_b32_dpp v160, v12, v36 row_newbcast:0 row_mask:0xf bank_mask:0xf
    v_and_b32_dpp v161, v12, v37 row_newbcast:0 row_mask:0xf bank_mask:0xf
    v_and_b32_dpp v162, v12, v38 row_newbcast:0 row_mask:0xf bank_mask:0xf
    v_and_b32_dpp v163, v12, v39 row_newbcast:0 row_mask:0xf bank_mask:0xf
    v_and_b32_dpp v76, v12, v36 row_newbcast:1 row_mask:0xf bank_mask:0xf
    v_and_b32_dpp v77, v12, v37 row_newbcast:1 row_mask:0xf bank_mask:0xf
    v_and_b32_dpp v78, v12, v38 row_newbcast:1 row_mask:0xf bank_mask:0xf
    v_and_b32_dpp v79, v12, v39 row_newbcast:1 row_mask:0xf bank_mask:0xf
    v_and_b32_dpp v80, v12, v36 row_newbcast:2 row_mask:0xf bank_mask:0xf
    v_and_b32_dpp v81, v12, v37 row_newbcast:2 row_mask:0xf bank_mask:0xf
    v_and_b32_dpp v82, v12, v38 row_newbcast:2 row_mask:0xf bank_mask:0xf
    v_and_b32_dpp v83, v12, v39 row_newbcast:2 row_mask:0xf bank_mask:0xf
    v_and_b32_dpp v84, v12, v36 row_newbcast:3 row_mask:0xf bank_mask:0xf
    v_and_b32_dpp v85, v12, v37 row_newbcast:3 row_mask:0xf bank_mask:0xf
    v_and_b32_dpp v86, v12, v38 row_newbcast:3 row_mask:0xf bank_mask:0xf
    v_and_b32_dpp v87, v12, v39 row_newbcast:3 row_mask:0xf bank_mask:0xf
    v_and_b32_dpp v88, v12, v36 row_newbcast:4 row_mask:0xf bank_mask:0xf
    v_and_b32_dpp v89, v12, v37 row_newbcast:4 row_mask:0xf bank_mask:0xf
    v_and_b32_dpp v90, v12, v38 row_newbcast:4 row_mask:0xf bank_mask:0xf
    v_and_b32_dpp v91, v12, v39 row_newbcast:4 row_mask:0xf bank_mask:0xf
    v_and_b32_dpp v92, v12, v36 row_newbcast:5 row_mask:0xf bank_mask:0xf
    v_and_b32_dpp v93, v12, v37 row_newbcast:5 row_mask:0xf bank_mask:0xf
    v_and_b32_dpp v94, v12, v38 row_newbcast:5 row_mask:0xf bank_mask:0xf
    v_and_b32_dpp v95, v12, v39 row_newbcast:5 row_mask:0xf bank_mask:0xf
    s_barrier
    buffer_load_dwordx4 v[96:99], v3, s[48:51], 0 offen
    s_mov_b32 s87, 5120
    buffer_load_dwordx4 v[100:103], v3, s[48:51], s87 offen
    s_mov_b32 s87, 10240
    buffer_load_dwordx4 v[104:107], v3, s[48:51], s87 offen
    s_mov_b32 s87, 15360
    buffer_load_dwordx4 v[108:111], v3, s[48:51], s87 offen
    v_and_b32 v40, v22, v36
    v_and_b32 v41, v22, v37
    v_and_b32 v42, v22, v38
    v_and_b32 v43, v22, v39
    s_nop 1
    v_mfma_f32_16x16x32_bf16 v[24:27], v[40:43], v[132:135], v[24:27]
    v_mfma_f32_16x16x32_bf16 v[28:31], v[40:43], v[136:139], v[28:31]
    s_waitcnt vmcnt(8)
    v_mfma_f32_16x16x32_bf16 v[32:35], v[40:43], v[140:143], v[32:35]
    s_mov_b32 s87, 20480
    buffer_load_dwordx4 v[112:115], v3, s[48:51], s87 offen
    v_and_b32 v44, v23, v36
    v_and_b32 v45, v23, v37
    v_and_b32 v46, v23, v38
    v_and_b32 v47, v23, v39
    s_waitcnt vmcnt(8)
    s_nop 0
    v_mfma_f32_16x16x32_bf16 v[24:27], v[44:47], v[144:147], v[24:27]
    s_mov_b32 s87, 25600
    buffer_load_dwordx4 v[116:119], v3, s[48:51], s87 offen
    s_waitcnt vmcnt(8)
    v_mfma_f32_16x16x32_bf16 v[28:31], v[44:47], v[148:151], v[28:31]
    buffer_load_dwordx4 v[120:123], v4, s[52:55], 0 offen offset:0
    s_waitcnt vmcnt(7)
    v_mfma_f32_16x16x32_bf16 v[32:35], v[44:47], v[156:159], v[32:35]
    s_mov_b32 exec_lo, 0x00ff00ff
    s_mov_b32 exec_hi, 0xff00ff00
    ds_write_b128 v48, v[24:27] offset:13568
    s_nop 1
    ds_write_b128 v48, v[28:31] offset:13824
    s_nop 1
    ds_write_b128 v48, v[32:35] offset:14080
    s_mov_b64 exec, -1
    s_waitcnt lgkmcnt(0)
    s_barrier
    ds_read_b128 v[8:11], v49 offset:13568
    ds_read_b128 v[12:15], v49 offset:14416
    v_and_b32 v40, v72, v36
    v_and_b32 v41, v72, v37
    v_and_b32 v42, v72, v38
    v_and_b32 v43, v72, v39
    v_and_b32 v44, v73, v36
    v_and_b32 v45, v73, v37
    v_and_b32 v46, v73, v38
    v_and_b32 v47, v73, v39
    s_waitcnt lgkmcnt(0)
    v_add_f32 v8, v8, v12
    v_add_f32 v9, v9, v13
    v_add_f32 v10, v10, v14
    v_add_f32 v11, v11, v15
    v_permlane16_swap_b32 v8, v9
    s_nop 0
    v_permlane16_swap_b32 v10, v11
    v_add_f32 v8, v8, v9
    v_add_f32 v10, v10, v11
    s_nop 1
    v_permlane32_swap_b32 v8, v10
    v_add_f32 v8, v8, v10
    s_nop 1
    v_add_f32_dpp v8, v8, v8 row_ror:8 row_mask:0xf bank_mask:0xf
    v_and_or_b32 v8, v8, s77, v75
    s_cmp_eq_u32 s89, 1
    s_cbranch_scc1 L_ofast1
    buffer_store_dword v8, v56, s[68:71], s100 offen offset:1024 sc1
    s_branch L_odone1
L_ofast1:
    buffer_store_dword v8, v56, s[68:71], s100 offen offset:1024
L_odone1:
    buffer_load_dword v16, v57, s[68:71], s93 offen offset:1024 sc1
    buffer_load_dword v17, v57, s[68:71], s94 offen offset:1024 sc1
    buffer_load_dword v18, v57, s[68:71], s95 offen offset:1024 sc1
    buffer_load_dword v19, v57, s[68:71], s98 offen offset:1024 sc1
    s_waitcnt vmcnt(5)
    v_mfma_f32_16x16x32_bf16 v[24:27], v[40:43], v[120:123], 0
    v_mfma_f32_16x16x32_bf16 v[24:27], v[44:47], v[152:155], v[24:27]
L_poll1:
    s_waitcnt vmcnt(0)
    v_xor_b32 v16, s78, v16
    v_xor_b32 v17, s78, v17
    v_xor_b32 v18, s78, v18
    v_xor_b32 v19, s78, v19
    v_or3_b32 v66, v16, v17, v18
    v_or_b32 v66, v66, v19
    v_and_b32 v66, 1023, v66
    v_cmp_ne_u32 vcc, 0, v66
    v_add_f32 v20, v16, v17
    v_add_f32 v21, v18, v19
    s_cbranch_vccz L_poll1d
    buffer_load_dword v16, v57, s[68:71], s93 offen offset:1024 sc1
    buffer_load_dword v17, v57, s[68:71], s94 offen offset:1024 sc1
    buffer_load_dword v18, v57, s[68:71], s95 offen offset:1024 sc1
    buffer_load_dword v19, v57, s[68:71], s98 offen offset:1024 sc1
    s_sub_u32 s92, s92, 1
    s_cbranch_scc0 L_poll1
    s_endpgm
L_poll1d:
    v_add_f32 v16, v20, v21
    s_nop 1
    v_add_f32_dpp v16, v16, v16 row_ror:8 row_mask:0xf bank_mask:0xf
    v_cvt_pk_bf16_f32 v16, v16, v16
    s_nop 1
    v_and_b32_dpp v160, v16, v36 row_newbcast:0 row_mask:0xf bank_mask:0xc
    v_and_b32_dpp v161, v16, v37 row_newbcast:0 row_mask:0xf bank_mask:0xc
    v_and_b32_dpp v162, v16, v38 row_newbcast:0 row_mask:0xf bank_mask:0xc
    v_and_b32_dpp v163, v16, v39 row_newbcast:0 row_mask:0xf bank_mask:0xc
    v_and_b32_dpp v76, v16, v36 row_newbcast:1 row_mask:0xf bank_mask:0xc
    v_and_b32_dpp v77, v16, v37 row_newbcast:1 row_mask:0xf bank_mask:0xc
    v_and_b32_dpp v78, v16, v38 row_newbcast:1 row_mask:0xf bank_mask:0xc
    v_and_b32_dpp v79, v16, v39 row_newbcast:1 row_mask:0xf bank_mask:0xc
    v_mfma_f32_16x16x32_bf16 v[24:27], v[160:163], v[96:99], v[24:27]
    v_and_b32_dpp v80, v16, v36 row_newbcast:2 row_mask:0xf bank_mask:0xc
    v_and_b32_dpp v81, v16, v37 row_newbcast:2 row_mask:0xf bank_mask:0xc
    v_and_b32_dpp v82, v16, v38 row_newbcast:2 row_mask:0xf bank_mask:0xc
    v_and_b32_dpp v83, v16, v39 row_newbcast:2 row_mask:0xf bank_mask:0xc
    v_mfma_f32_16x16x32_bf16 v[24:27], v[76:79], v[100:103], v[24:27]
    v_and_b32_dpp v84, v16, v36 row_newbcast:3 row_mask:0xf bank_mask:0xc
    v_and_b32_dpp v85, v16, v37 row_newbcast:3 row_mask:0xf bank_mask:0xc
    v_and_b32_dpp v86, v16, v38 row_newbcast:3 row_mask:0xf bank_mask:0xc
    v_and_b32_dpp v87, v16, v39 row_newbcast:3 row_mask:0xf bank_mask:0xc
    v_mfma_f32_16x16x32_bf16 v[24:27], v[80:83], v[104:107], v[24:27]
    v_and_b32_dpp v88, v16, v36 row_newbcast:4 row_mask:0xf bank_mask:0xc
    v_and_b32_dpp v89, v16, v37 row_newbcast:4 row_mask:0xf bank_mask:0xc
    v_and_b32_dpp v90, v16, v38 row_newbcast:4 row_mask:0xf bank_mask:0xc
    v_and_b32_dpp v91, v16, v39 row_newbcast:4 row_mask:0xf bank_mask:0xc
    v_mfma_f32_16x16x32_bf16 v[24:27], v[84:87], v[108:111], v[24:27]
    v_and_b32_dpp v92, v16, v36 row_newbcast:5 row_mask:0xf bank_mask:0xc
    v_and_b32_dpp v93, v16, v37 row_newbcast:5 row_mask:0xf bank_mask:0xc
    v_and_b32_dpp v94, v16, v38 row_newbcast:5 row_mask:0xf bank_mask:0xc
    v_and_b32_dpp v95, v16, v39 row_newbcast:5 row_mask:0xf bank_mask:0xc
    v_mfma_f32_16x16x32_bf16 v[24:27], v[88:91], v[112:115], v[24:27]
    s_nop 0
    v_mfma_f32_16x16x32_bf16 v[24:27], v[92:95], v[116:119], v[24:27]
    s_mov_b32 exec_lo, 0x03ff03ff
    s_mov_b32 exec_hi, 0x03ff03ff
    s_cmp_ge_u32 s3, 1
    s_nop 4
    ds_write_b128 v52, v[24:27] offset:28880
    s_mov_b64 exec, -1
    s_waitcnt lgkmcnt(0)
    s_barrier
    s_cbranch_scc1 L_fin
    s_mov_b32 exec_hi, 0xff
    ds_read_b128 v[8:11], v53 offset:28880
    ds_read_b128 v[12:15], v53 offset:29520
    ds_read_b128 v[16:19], v53 offset:30160
    ds_read_b128 v[20:23], v53 offset:30800
    ds_read_b128 v[28:31], v53 offset:31440
    ds_read_b128 v[32:35], v53 offset:32080
    ds_read_b128 v[40:43], v53 offset:32720
    ds_read_b128 v[44:47], v53 offset:33360
    s_waitcnt lgkmcnt(6)
    v_pk_add_f32 v[8:9], v[8:9], v[12:13]
    v_pk_add_f32 v[10:11], v[10:11], v[14:15]
    s_waitcnt lgkmcnt(4)
    v_pk_add_f32 v[16:17], v[16:17], v[20:21]
    v_pk_add_f32 v[18:19], v[18:19], v[22:23]
    s_waitcnt lgkmcnt(2)
    v_pk_add_f32 v[28:29], v[28:29], v[32:33]
    v_pk_add_f32 v[30:31], v[30:31], v[34:35]
    s_waitcnt lgkmcnt(0)
    v_pk_add_f32 v[40:41], v[40:41], v[44:45]
    v_pk_add_f32 v[42:43], v[42:43], v[46:47]
    v_pk_add_f32 v[8:9], v[8:9], v[16:17]
    v_pk_add_f32 v[10:11], v[10:11], v[18:19]
    v_pk_add_f32 v[28:29], v[28:29], v[40:41]
    v_pk_add_f32 v[30:31], v[30:31], v[42:43]
    v_pk_add_f32 v[8:9], v[8:9], v[28:29]
    v_pk_add_f32 v[10:11], v[10:11], v[30:31]
    v_and_or_b32 v8, v8, s77, v75
    v_and_or_b32 v9, v9, s77, v75
    v_and_or_b32 v10, v10, s77, v75
    v_and_or_b32 v11, v11, s77, v75
    buffer_store_dwordx4 v[8:11], v53, s[68:71], s101 offen sc1
    s_mov_b32 exec_hi, -1
L_fin:
L_end:
    s_endpgm
L_helper:
    v_mul_u32_u24 v3, 122880, v6
    v_add_u32 v3, v3, v5
    v_mul_u32_u24 v4, 30720, v6
    v_add_u32 v4, v4, v5
    v_mov_b32 v2, 2147483648
    v_cmp_gt_u32 vcc, 6, v7
    s_nop 1
    v_cndmask_b32 v4, v2, v4, vcc
    v_mul_u32_u24 v8, 20, v6
    v_lshlrev_b32 v9, 4, v1
    v_mov_b32 v73, 0
    ds_write_b32 v73, v73 offset:28800
    ds_write_b32 v73, v73 offset:28808
    v_mov_b32 v10, 24
    ds_write_b32 v73, v10 offset:28804
    s_mul_i32 s83, s31, 983040
    s_mul_i32 s84, s30, 384
    s_add_u32 s83, s83, s84
    s_mul_i32 s85, s31, 245760
    s_mul_i32 s84, s30, 96
    s_add_u32 s85, s85, s84
    s_mul_i32 s98, s31, 160
    s_mov_b32 s43, 0x20000
    s_mov_b32 s47, 0x20000
    s_mov_b32 s59, 0x20000
    s_mov_b32 s63, 0x20000
    s_mov_b32 s67, 0x20000
    s_sub_u32 s42, 7864320, s83
    s_sub_u32 s46, 1966080, s85
    s_sub_u32 s58, 2560, s98
    s_sub_u32 s62, 1280, s98
    s_mov_b32 s66, 96
    s_waitcnt lgkmcnt(0)
    s_add_u32 s56, s4, s98
    s_addc_u32 s57, s5, 0
    s_add_u32 s40, s10, s83
    s_addc_u32 s41, s11, 0
    s_add_u32 s44, s16, s85
    s_addc_u32 s45, s17, 0
    s_add_u32 s60, s22, s98
    s_addc_u32 s61, s23, 0
    s_add_u32 s64, s18, s84
    s_addc_u32 s65, s19, 0
    buffer_load_dwordx4 v[56:59], v8, s[56:59], 0 offen
    buffer_load_dword v60, v8, s[56:59], 0 offen offset:16
    buffer_load_dwordx4 v[62:65], v8, s[56:59], 0 offen offset:1280
    buffer_load_dword v66, v8, s[56:59], 0 offen offset:1296
    buffer_load_dwordx4 v[76:79], v3, s[40:43], 0 offen offset:0 nt
    buffer_load_dwordx4 v[80:83], v3, s[40:43], 0 offen offset:128 nt
    buffer_load_dwordx4 v[84:87], v3, s[40:43], 0 offen offset:256 nt
    buffer_load_dwordx4 v[88:91], v4, s[44:47], 0 offen nt
    s_mov_b32 s87, 12288
    s_mov_b32 s86, 3072
    buffer_load_dwordx4 v[92:95], v3, s[40:43], s87 offen offset:0 nt
    buffer_load_dwordx4 v[96:99], v3, s[40:43], s87 offen offset:128 nt
    buffer_load_dwordx4 v[100:103], v3, s[40:43], s87 offen offset:256 nt
    buffer_load_dwordx4 v[104:107], v4, s[44:47], s86 offen nt
    s_mov_b32 s87, 24576
    s_mov_b32 s86, 6144
    buffer_load_dwordx4 v[108:111], v3, s[40:43], s87 offen offset:0 nt
    buffer_load_dwordx4 v[112:115], v3, s[40:43], s87 offen offset:128 nt
    buffer_load_dwordx4 v[116:119], v3, s[40:43], s87 offen offset:256 nt
    buffer_load_dwordx4 v[120:123], v4, s[44:47], s86 offen nt
    s_mov_b32 s87, 36864
    s_mov_b32 s86, 9216
    buffer_load_dwordx4 v[124:127], v3, s[40:43], s87 offen offset:0 nt
    buffer_load_dwordx4 v[128:131], v3, s[40:43], s87 offen offset:128 nt
    buffer_load_dwordx4 v[132:135], v3, s[40:43], s87 offen offset:256 nt
    buffer_load_dwordx4 v[136:139], v4, s[44:47], s86 offen nt
    s_mov_b32 s87, 49152
    s_mov_b32 s86, 12288
    buffer_load_dwordx4 v[140:143], v3, s[40:43], s87 offen offset:0 nt
    buffer_load_dwordx4 v[144:147], v3, s[40:43], s87 offen offset:128 nt
    buffer_load_dwordx4 v[148:151], v3, s[40:43], s87 offen offset:256 nt
    buffer_load_dwordx4 v[152:155], v4, s[44:47], s86 offen nt
    buffer_load_dwordx4 v[68:71], v8, s[60:63], 0 offen
    buffer_load_dword v72, v8, s[60:63], 0 offen offset:16
    v_and_b32 v10, 15, v1
    v_lshlrev_b32 v10, 3, v10
    buffer_load_dwordx2 v[74:75], v10, s[64:67], 0 offen
    s_barrier
    s_mov_b32 s89, 0x01000100
    s_mov_b32 s90, 0x03020302
    s_mov_b32 s91, 0x3f803f80
    v_and_b32 v10, 1, v1
    v_lshlrev_b32 v10, 4, v10
    v_mov_b32 v11, 0xffff
    v_lshlrev_b32 v10, v10, v11
    v_bfe_u32 v11, v1, 1, 2
    v_cmp_eq_u32 vcc, 0, v11
    s_nop 1
    v_cndmask_b32 v12, 0, v10, vcc
    v_cmp_eq_u32 vcc, 1, v11
    s_nop 1
    v_cndmask_b32 v13, 0, v10, vcc
    v_cmp_eq_u32 vcc, 2, v11
    s_nop 1
    v_cndmask_b32 v14, 0, v10, vcc
    v_cmp_eq_u32 vcc, 3, v11
    s_nop 1
    v_cndmask_b32 v15, 0, v10, vcc
    s_mov_b32 s68, s28
    s_mov_b32 s69, s29
    s_mov_b32 s70, 4194304
    s_mov_b32 s71, 0x20000
    s_lshl_b32 s99, s30, 3
    s_add_u32 s99, s99, s31
    s_lshl_b32 s99, s99, 11
    s_add_u32 s100, s99, 524288
    s_lshl_b32 s101, s31, 5
    s_add_u32 s101, s101, s30
    s_mul_i32 s101, s101, 640
    s_add_u32 s101, s101, 1572864
    s_mov_b32 s92, 262144
    s_mov_b32 s76, 1835008
    s_load_dword s79, s[28:29], s76
    s_mov_b32 s77, 4294966272
    v_lshlrev_b32 v2, 7, v1
    s_add_u32 s82, s99, 1048576
    s_mov_b64 exec, 0xffff
    buffer_load_dword v164, v2, s[68:71], s82 offen
    s_mov_b64 exec, 0xffff
    buffer_load_dword v164, v2, s[68:71], s100 offen
    s_mov_b64 exec, 31
    buffer_load_dword v164, v2, s[68:71], s101 offen
    s_and_b32 s82, s2, 7
    s_mul_i32 s83, s82, 4352
    s_add_u32 s83, s83, 1839104
    s_mov_b64 exec, 3
    buffer_load_dword v164, v2, s[68:71], s83 offen
    s_mov_b64 exec, -1
    s_waitcnt vmcnt(23)
    v_perm_b32 v11, v56, v56, s89
    v_and_b32 v16, v11, v12
    v_and_b32 v17, v11, v13
    v_and_b32 v18, v11, v14
    v_and_b32 v19, v11, v15
    s_nop 1
    v_mfma_f32_16x16x32_bf16 v[24:27], v[16:19], v[76:79], 0
    v_mfma_f32_16x16x32_bf16 v[28:31], v[16:19], v[80:83], 0
    v_mfma_f32_16x16x32_bf16 v[32:35], v[16:19], v[84:87], 0
    v_mfma_f32_16x16x32_bf16 v[36:39], v[16:19], v[88:91], 0
    v_perm_b32 v11, v62, v62, s89
    v_and_b32 v20, v11, v12
    v_and_b32 v21, v11, v13
    v_and_b32 v22, v11, v14
    v_and_b32 v23, v11, v15
    s_nop 1
    v_mfma_f32_16x16x32_bf16 v[40:43], v[20:23], v[76:79], 0
    v_mfma_f32_16x16x32_bf16 v[44:47], v[20:23], v[80:83], 0
    v_mfma_f32_16x16x32_bf16 v[48:51], v[20:23], v[84:87], 0
    v_mfma_f32_16x16x32_bf16 v[52:55], v[20:23], v[88:91], 0
    s_mov_b32 s87, 61440
    s_mov_b32 s86, 15360
    buffer_load_dwordx4 v[156:159], v3, s[40:43], s87 offen offset:0 nt
    buffer_load_dwordx4 v[160:163], v3, s[40:43], s87 offen offset:128 nt
    buffer_load_dwordx4 v[76:79], v3, s[40:43], s87 offen offset:256 nt
    buffer_load_dwordx4 v[80:83], v4, s[44:47], s86 offen nt
    s_waitcnt vmcnt(23)
    v_perm_b32 v11, v56, v56, s90
    v_and_b32 v16, v11, v12
    v_and_b32 v17, v11, v13
    v_and_b32 v18, v11, v14
    v_and_b32 v19, v11, v15
    s_nop 1
    v_mfma_f32_16x16x32_bf16 v[24:27], v[16:19], v[92:95], v[24:27]
    v_mfma_f32_16x16x32_bf16 v[28:31], v[16:19], v[96:99], v[28:31]
    v_mfma_f32_16x16x32_bf16 v[32:35], v[16:19], v[100:103], v[32:35]
    v_mfma_f32_16x16x32_bf16 v[36:39], v[16:19], v[104:107], v[36:39]
    v_perm_b32 v11, v62, v62, s90
    v_and_b32 v20, v11, v12
    v_and_b32 v21, v11, v13
    v_and_b32 v22, v11, v14
    v_and_b32 v23, v11, v15
    s_nop 1
    v_mfma_f32_16x16x32_bf16 v[40:43], v[20:23], v[92:95], v[40:43]
    v_mfma_f32_16x16x32_bf16 v[44:47], v[20:23], v[96:99], v[44:47]
    v_mfma_f32_16x16x32_bf16 v[48:51], v[20:23], v[100:103], v[48:51]
    v_mfma_f32_16x16x32_bf16 v[52:55], v[20:23], v[104:107], v[52:55]
    s_mov_b32 s87, 73728
    s_mov_b32 s86, 18432
    buffer_load_dwordx4 v[84:87], v3, s[40:43], s87 offen offset:0 nt
    buffer_load_dwordx4 v[88:91], v3, s[40:43], s87 offen offset:128 nt
    buffer_load_dwordx4 v[92:95], v3, s[40:43], s87 offen offset:256 nt
    buffer_load_dwordx4 v[96:99], v4, s[44:47], s86 offen nt
    s_waitcnt vmcnt(23)
    v_perm_b32 v11, v57, v57, s89
    v_and_b32 v16, v11, v12
    v_and_b32 v17, v11, v13
    v_and_b32 v18, v11, v14
    v_and_b32 v19, v11, v15
    s_nop 1
    v_mfma_f32_16x16x32_bf16 v[24:27], v[16:19], v[108:111], v[24:27]
    v_mfma_f32_16x16x32_bf16 v[28:31], v[16:19], v[112:115], v[28:31]
    v_mfma_f32_16x16x32_bf16 v[32:35], v[16:19], v[116:119], v[32:35]
    v_mfma_f32_16x16x32_bf16 v[36:39], v[16:19], v[120:123], v[36:39]
    v_perm_b32 v11, v63, v63, s89
    v_and_b32 v20, v11, v12
    v_and_b32 v21, v11, v13
    v_and_b32 v22, v11, v14
    v_and_b32 v23, v11, v15
    s_nop 1
    v_mfma_f32_16x16x32_bf16 v[40:43], v[20:23], v[108:111], v[40:43]
    v_mfma_f32_16x16x32_bf16 v[44:47], v[20:23], v[112:115], v[44:47]
    v_mfma_f32_16x16x32_bf16 v[48:51], v[20:23], v[116:119], v[48:51]
    v_mfma_f32_16x16x32_bf16 v[52:55], v[20:23], v[120:123], v[52:55]
    s_mov_b32 s87, 86016
    s_mov_b32 s86, 21504
    buffer_load_dwordx4 v[100:103], v3, s[40:43], s87 offen offset:0 nt
    buffer_load_dwordx4 v[104:107], v3, s[40:43], s87 offen offset:128 nt
    buffer_load_dwordx4 v[108:111], v3, s[40:43], s87 offen offset:256 nt
    buffer_load_dwordx4 v[112:115], v4, s[44:47], s86 offen nt
    s_waitcnt vmcnt(23)
    v_perm_b32 v11, v57, v57, s90
    v_and_b32 v16, v11, v12
    v_and_b32 v17, v11, v13
    v_and_b32 v18, v11, v14
    v_and_b32 v19, v11, v15
    s_nop 1
    v_mfma_f32_16x16x32_bf16 v[24:27], v[16:19], v[124:127], v[24:27]
    v_mfma_f32_16x16x32_bf16 v[28:31], v[16:19], v[128:131], v[28:31]
    v_mfma_f32_16x16x32_bf16 v[32:35], v[16:19], v[132:135], v[32:35]
    v_mfma_f32_16x16x32_bf16 v[36:39], v[16:19], v[136:139], v[36:39]
    v_perm_b32 v11, v63, v63, s90
    v_and_b32 v20, v11, v12
    v_and_b32 v21, v11, v13
    v_and_b32 v22, v11, v14
    v_and_b32 v23, v11, v15
    s_nop 1
    v_mfma_f32_16x16x32_bf16 v[40:43], v[20:23], v[124:127], v[40:43]
    v_mfma_f32_16x16x32_bf16 v[44:47], v[20:23], v[128:131], v[44:47]
    v_mfma_f32_16x16x32_bf16 v[48:51], v[20:23], v[132:135], v[48:51]
    v_mfma_f32_16x16x32_bf16 v[52:55], v[20:23], v[136:139], v[52:55]
    s_mov_b32 s87, 98304
    s_mov_b32 s86, 24576
    buffer_load_dwordx4 v[116:119], v3, s[40:43], s87 offen offset:0 nt
    buffer_load_dwordx4 v[120:123], v3, s[40:43], s87 offen offset:128 nt
    buffer_load_dwordx4 v[124:127], v3, s[40:43], s87 offen offset:256 nt
    buffer_load_dwordx4 v[128:131], v4, s[44:47], s86 offen nt
    s_waitcnt vmcnt(23)
    v_perm_b32 v11, v58, v58, s89
    v_and_b32 v16, v11, v12
    v_and_b32 v17, v11, v13
    v_and_b32 v18, v11, v14
    v_and_b32 v19, v11, v15
    s_nop 1
    v_mfma_f32_16x16x32_bf16 v[24:27], v[16:19], v[140:143], v[24:27]
    v_mfma_f32_16x16x32_bf16 v[28:31], v[16:19], v[144:147], v[28:31]
    v_mfma_f32_16x16x32_bf16 v[32:35], v[16:19], v[148:151], v[32:35]
    v_mfma_f32_16x16x32_bf16 v[36:39], v[16:19], v[152:155], v[36:39]
    v_perm_b32 v11, v64, v64, s89
    v_and_b32 v20, v11, v12
    v_and_b32 v21, v11, v13
    v_and_b32 v22, v11, v14
    v_and_b32 v23, v11, v15
    s_nop 1
    v_mfma_f32_16x16x32_bf16 v[40:43], v[20:23], v[140:143], v[40:43]
    v_mfma_f32_16x16x32_bf16 v[44:47], v[20:23], v[144:147], v[44:47]
    v_mfma_f32_16x16x32_bf16 v[48:51], v[20:23], v[148:151], v[48:51]
    v_mfma_f32_16x16x32_bf16 v[52:55], v[20:23], v[152:155], v[52:55]
    s_mov_b32 s87, 110592
    s_mov_b32 s86, 27648
    buffer_load_dwordx4 v[132:135], v3, s[40:43], s87 offen offset:0 nt
    buffer_load_dwordx4 v[136:139], v3, s[40:43], s87 offen offset:128 nt
    buffer_load_dwordx4 v[140:143], v3, s[40:43], s87 offen offset:256 nt
    buffer_load_dwordx4 v[144:147], v4, s[44:47], s86 offen nt
    s_waitcnt vmcnt(16)
    v_perm_b32 v11, v58, v58, s90
    v_and_b32 v16, v11, v12
    v_and_b32 v17, v11, v13
    v_and_b32 v18, v11, v14
    v_and_b32 v19, v11, v15
    s_nop 1
    v_mfma_f32_16x16x32_bf16 v[24:27], v[16:19], v[156:159], v[24:27]
    v_mfma_f32_16x16x32_bf16 v[28:31], v[16:19], v[160:163], v[28:31]
    v_mfma_f32_16x16x32_bf16 v[32:35], v[16:19], v[76:79], v[32:35]
    v_mfma_f32_16x16x32_bf16 v[36:39], v[16:19], v[80:83], v[36:39]
    v_perm_b32 v11, v64, v64, s90
    v_and_b32 v20, v11, v12
    v_and_b32 v21, v11, v13
    v_and_b32 v22, v11, v14
    v_and_b32 v23, v11, v15
    s_nop 1
    v_mfma_f32_16x16x32_bf16 v[40:43], v[20:23], v[156:159], v[40:43]
    v_mfma_f32_16x16x32_bf16 v[44:47], v[20:23], v[160:163], v[44:47]
    v_mfma_f32_16x16x32_bf16 v[48:51], v[20:23], v[76:79], v[48:51]
    v_mfma_f32_16x16x32_bf16 v[52:55], v[20:23], v[80:83], v[52:55]
    s_waitcnt vmcnt(12)
    v_perm_b32 v11, v59, v59, s89
    v_and_b32 v16, v11, v12
    v_and_b32 v17, v11, v13
    v_and_b32 v18, v11, v14
    v_and_b32 v19, v11, v15
    s_nop 1
    v_mfma_f32_16x16x32_bf16 v[24:27], v[16:19], v[84:87], v[24:27]
    v_mfma_f32_16x16x32_bf16 v[28:31], v[16:19], v[88:91], v[28:31]
    v_mfma_f32_16x16x32_bf16 v[32:35], v[16:19], v[92:95], v[32:35]
    v_mfma_f32_16x16x32_bf16 v[36:39], v[16:19], v[96:99], v[36:39]
    v_perm_b32 v11, v65, v65, s89
    v_and_b32 v20, v11, v12
    v_and_b32 v21, v11, v13
    v_and_b32 v22, v11, v14
    v_and_b32 v23, v11, v15
    s_nop 1
    v_mfma_f32_16x16x32_bf16 v[40:43], v[20:23], v[84:87], v[40:43]
    v_mfma_f32_16x16x32_bf16 v[44:47], v[20:23], v[88:91], v[44:47]
    v_mfma_f32_16x16x32_bf16 v[48:51], v[20:23], v[92:95], v[48:51]
    v_mfma_f32_16x16x32_bf16 v[52:55], v[20:23], v[96:99], v[52:55]
    v_lshlrev_b32 v2, 16, v56
    v_lshlrev_b32 v10, 16, v68
    v_mul_f32 v2, v2, v10
    v_and_b32 v8, 0xffff0000, v56
    v_and_b32 v10, 0xffff0000, v68
    v_mul_f32 v8, v8, v10
    v_cvt_pk_bf16_f32 v2, v2, v8
    v_dot2_f32_bf16 v61, v2, s91, 0
    v_lshlrev_b32 v2, 16, v57
    v_lshlrev_b32 v10, 16, v69
    v_mul_f32 v2, v2, v10
    v_and_b32 v8, 0xffff0000, v57
    v_and_b32 v10, 0xffff0000, v69
    v_mul_f32 v8, v8, v10
    v_cvt_pk_bf16_f32 v2, v2, v8
    v_dot2_f32_bf16 v61, v2, s91, v61
    v_lshlrev_b32 v2, 16, v58
    v_lshlrev_b32 v10, 16, v70
    v_mul_f32 v2, v2, v10
    v_and_b32 v8, 0xffff0000, v58
    v_and_b32 v10, 0xffff0000, v70
    v_mul_f32 v8, v8, v10
    v_cvt_pk_bf16_f32 v2, v2, v8
    v_dot2_f32_bf16 v61, v2, s91, v61
    v_lshlrev_b32 v2, 16, v59
    v_lshlrev_b32 v10, 16, v71
    v_mul_f32 v2, v2, v10
    v_and_b32 v8, 0xffff0000, v59
    v_and_b32 v10, 0xffff0000, v71
    v_mul_f32 v8, v8, v10
    v_cvt_pk_bf16_f32 v2, v2, v8
    v_dot2_f32_bf16 v61, v2, s91, v61
    v_lshlrev_b32 v2, 16, v60
    v_lshlrev_b32 v10, 16, v72
    v_mul_f32 v2, v2, v10
    v_and_b32 v8, 0xffff0000, v60
    v_and_b32 v10, 0xffff0000, v72
    v_mul_f32 v8, v8, v10
    v_cvt_pk_bf16_f32 v2, v2, v8
    v_dot2_f32_bf16 v61, v2, s91, v61
    v_lshlrev_b32 v2, 16, v62
    v_lshlrev_b32 v10, 16, v68
    v_mul_f32 v2, v2, v10
    v_and_b32 v8, 0xffff0000, v62
    v_and_b32 v10, 0xffff0000, v68
    v_mul_f32 v8, v8, v10
    v_cvt_pk_bf16_f32 v2, v2, v8
    v_dot2_f32_bf16 v67, v2, s91, 0
    v_lshlrev_b32 v2, 16, v63
    v_lshlrev_b32 v10, 16, v69
    v_mul_f32 v2, v2, v10
    v_and_b32 v8, 0xffff0000, v63
    v_and_b32 v10, 0xffff0000, v69
    v_mul_f32 v8, v8, v10
    v_cvt_pk_bf16_f32 v2, v2, v8
    v_dot2_f32_bf16 v67, v2, s91, v67
    v_lshlrev_b32 v2, 16, v64
    v_lshlrev_b32 v10, 16, v70
    v_mul_f32 v2, v2, v10
    v_and_b32 v8, 0xffff0000, v64
    v_and_b32 v10, 0xffff0000, v70
    v_mul_f32 v8, v8, v10
    v_cvt_pk_bf16_f32 v2, v2, v8
    v_dot2_f32_bf16 v67, v2, s91, v67
    v_lshlrev_b32 v2, 16, v65
    v_lshlrev_b32 v10, 16, v71
    v_mul_f32 v2, v2, v10
    v_and_b32 v8, 0xffff0000, v65
    v_and_b32 v10, 0xffff0000, v71
    v_mul_f32 v8, v8, v10
    v_cvt_pk_bf16_f32 v2, v2, v8
    v_dot2_f32_bf16 v67, v2, s91, v67
    v_lshlrev_b32 v2, 16, v66
    v_lshlrev_b32 v10, 16, v72
    v_mul_f32 v2, v2, v10
    v_and_b32 v8, 0xffff0000, v66
    v_and_b32 v10, 0xffff0000, v72
    v_mul_f32 v8, v8, v10
    v_cvt_pk_bf16_f32 v2, v2, v8
    v_dot2_f32_bf16 v67, v2, s91, v67
    v_add_f32_dpp v61, v61, v61 row_ror:8 row_mask:0xf bank_mask:0xf
    v_mov_b32 v10, v61
    s_nop 1
    v_permlane16_swap_b32 v61, v10
    v_add_f32 v61, v61, v10
    v_mov_b32 v10, v61
    s_nop 1
    v_permlane32_swap_b32 v61, v10
    v_add_f32 v61, v61, v10
    v_add_f32_dpp v67, v67, v67 row_ror:8 row_mask:0xf bank_mask:0xf
    v_mov_b32 v10, v67
    s_nop 1
    v_permlane16_swap_b32 v67, v10
    v_add_f32 v67, v67, v10
    v_mov_b32 v10, v67
    s_nop 1
    v_permlane32_swap_b32 v67, v10
    v_add_f32 v67, v67, v10
    s_waitcnt vmcnt(8)
    v_perm_b32 v11, v59, v59, s90
    v_and_b32 v16, v11, v12
    v_and_b32 v17, v11, v13
    v_and_b32 v18, v11, v14
    v_and_b32 v19, v11, v15
    s_nop 1
    v_mfma_f32_16x16x32_bf16 v[24:27], v[16:19], v[100:103], v[24:27]
    v_mfma_f32_16x16x32_bf16 v[28:31], v[16:19], v[104:107], v[28:31]
    v_mfma_f32_16x16x32_bf16 v[32:35], v[16:19], v[108:111], v[32:35]
    v_mfma_f32_16x16x32_bf16 v[36:39], v[16:19], v[112:115], v[36:39]
    v_perm_b32 v11, v65, v65, s90
    v_and_b32 v20, v11, v12
    v_and_b32 v21, v11, v13
    v_and_b32 v22, v11, v14
    v_and_b32 v23, v11, v15
    s_nop 1
    v_mfma_f32_16x16x32_bf16 v[40:43], v[20:23], v[100:103], v[40:43]
    v_mfma_f32_16x16x32_bf16 v[44:47], v[20:23], v[104:107], v[44:47]
    v_mfma_f32_16x16x32_bf16 v[48:51], v[20:23], v[108:111], v[48:51]
    v_mfma_f32_16x16x32_bf16 v[52:55], v[20:23], v[112:115], v[52:55]
    s_waitcnt vmcnt(4)
    v_perm_b32 v11, v60, v60, s89
    v_and_b32 v16, v11, v12
    v_and_b32 v17, v11, v13
    v_and_b32 v18, v11, v14
    v_and_b32 v19, v11, v15
    s_nop 1
    v_mfma_f32_16x16x32_bf16 v[24:27], v[16:19], v[116:119], v[24:27]
    v_mfma_f32_16x16x32_bf16 v[28:31], v[16:19], v[120:123], v[28:31]
    v_mfma_f32_16x16x32_bf16 v[32:35], v[16:19], v[124:127], v[32:35]
    v_mfma_f32_16x16x32_bf16 v[36:39], v[16:19], v[128:131], v[36:39]
    v_perm_b32 v11, v66, v66, s89
    v_and_b32 v20, v11, v12
    v_and_b32 v21, v11, v13
    v_and_b32 v22, v11, v14
    v_and_b32 v23, v11, v15
    s_nop 1
    v_mfma_f32_16x16x32_bf16 v[40:43], v[20:23], v[116:119], v[40:43]
    v_mfma_f32_16x16x32_bf16 v[44:47], v[20:23], v[120:123], v[44:47]
    v_mfma_f32_16x16x32_bf16 v[48:51], v[20:23], v[124:127], v[48:51]
    v_mfma_f32_16x16x32_bf16 v[52:55], v[20:23], v[128:131], v[52:55]
    s_waitcnt vmcnt(0)
    v_perm_b32 v11, v60, v60, s90
    v_and_b32 v16, v11, v12
    v_and_b32 v17, v11, v13
    v_and_b32 v18, v11, v14
    v_and_b32 v19, v11, v15
    s_nop 1
    v_mfma_f32_16x16x32_bf16 v[24:27], v[16:19], v[132:135], v[24:27]
    v_mfma_f32_16x16x32_bf16 v[28:31], v[16:19], v[136:139], v[28:31]
    v_mfma_f32_16x16x32_bf16 v[32:35], v[16:19], v[140:143], v[32:35]
    v_mfma_f32_16x16x32_bf16 v[36:39], v[16:19], v[144:147], v[36:39]
    v_perm_b32 v11, v66, v66, s90
    v_and_b32 v20, v11, v12
    v_and_b32 v21, v11, v13
    v_and_b32 v22, v11, v14
    v_and_b32 v23, v11, v15
    s_nop 1
    v_mfma_f32_16x16x32_bf16 v[40:43], v[20:23], v[132:135], v[40:43]
    v_mfma_f32_16x16x32_bf16 v[44:47], v[20:23], v[136:139], v[44:47]
    v_mfma_f32_16x16x32_bf16 v[48:51], v[20:23], v[140:143], v[48:51]
    v_mfma_f32_16x16x32_bf16 v[52:55], v[20:23], v[144:147], v[52:55]
    v_lshrrev_b32 v16, 5, v1
    v_lshlrev_b32 v16, 10, v16
    v_and_b32 v11, 1, v6
    v_lshl_add_u32 v16, v11, 8, v16
    v_lshl_add_u32 v16, v7, 5, v16
    v_bfe_u32 v11, v1, 4, 1
    v_lshl_add_u32 v16, v11, 4, v16
    v_permlane32_swap_b32 v24, v40
    v_permlane32_swap_b32 v25, v41
    v_permlane32_swap_b32 v26, v42
    v_permlane32_swap_b32 v27, v43
    v_permlane32_swap_b32 v28, v44
    v_permlane32_swap_b32 v29, v45
    v_permlane32_swap_b32 v30, v46
    v_permlane32_swap_b32 v31, v47
    v_permlane32_swap_b32 v32, v48
    v_permlane32_swap_b32 v33, v49
    v_permlane32_swap_b32 v34, v50
    v_permlane32_swap_b32 v35, v51
    v_permlane32_swap_b32 v36, v52
    v_permlane32_swap_b32 v37, v53
    v_permlane32_swap_b32 v38, v54
    v_permlane32_swap_b32 v39, v55
    v_add_f32_dpp v76, v40, v24 row_ror:8 row_mask:0xf bank_mask:0xf
    v_add_f32_dpp v77, v41, v25 row_ror:8 row_mask:0xf bank_mask:0xf
    v_add_f32_dpp v78, v42, v26 row_ror:8 row_mask:0xf bank_mask:0xf
    v_add_f32_dpp v79, v43, v27 row_ror:8 row_mask:0xf bank_mask:0xf
    v_add_f32_dpp v76, v28, v44 row_ror:8 row_mask:0xf bank_mask:0xc
    v_add_f32_dpp v77, v29, v45 row_ror:8 row_mask:0xf bank_mask:0xc
    v_add_f32_dpp v78, v30, v46 row_ror:8 row_mask:0xf bank_mask:0xc
    v_add_f32_dpp v79, v31, v47 row_ror:8 row_mask:0xf bank_mask:0xc
    v_add_f32_dpp v80, v48, v32 row_ror:8 row_mask:0xf bank_mask:0xf
    v_add_f32_dpp v81, v49, v33 row_ror:8 row_mask:0xf bank_mask:0xf
    v_add_f32_dpp v82, v50, v34 row_ror:8 row_mask:0xf bank_mask:0xf
    v_add_f32_dpp v83, v51, v35 row_ror:8 row_mask:0xf bank_mask:0xf
    v_add_f32_dpp v80, v36, v52 row_ror:8 row_mask:0xf bank_mask:0xc
    v_add_f32_dpp v81, v37, v53 row_ror:8 row_mask:0xf bank_mask:0xc
    v_add_f32_dpp v82, v38, v54 row_ror:8 row_mask:0xf bank_mask:0xc
    v_add_f32_dpp v83, v39, v55 row_ror:8 row_mask:0xf bank_mask:0xc
    s_mov_b64 exec, 16384
    v_mov_b32 v80, v61
    s_mov_b32 exec_lo, 0
    s_mov_b32 exec_hi, 16384
    v_mov_b32 v80, v67
    s_mov_b64 exec, -1
    s_getreg_b32 s88, hwreg(HW_REG_XCC_ID)
    s_and_b32 s88, s88, 15
    s_lshl_b32 s88, s88, 23
    v_writelane_b32 v81, s88, 14
    s_waitcnt lgkmcnt(0)
    s_add_u32 s79, s79, 1
    s_and_b32 s78, s79, 1023
    v_mov_b32 v11, s78
    v_and_or_b32 v76, v76, s77, v11
    v_and_or_b32 v77, v77, s77, v11
    v_and_or_b32 v78, v78, s77, v11
    v_and_or_b32 v79, v79, s77, v11
    v_and_or_b32 v80, v80, s77, v11
    v_and_or_b32 v81, v81, s77, v11
    v_and_or_b32 v82, v82, s77, v11
    v_and_or_b32 v83, v83, s77, v11
    s_add_u32 s82, s99, 1048576
    buffer_store_dwordx4 v[76:79], v16, s[68:71], s82 offen
    buffer_store_dwordx4 v[80:83], v16, s[68:71], s82 offen offset:512
    v_add_u32 v12, 4096, v9
    s_lshl_b32 s93, s30, 14
    s_add_u32 s93, s93, 1048576
    s_add_u32 s94, s93, 8192
    s_mov_b32 s76, 48
    v_lshlrev_b32 v17, 11, v6
    v_and_b32 v18, 3, v1
    v_lshl_add_u32 v17, v18, 4, v17
    v_bfe_u32 v18, v1, 2, 1
    v_lshl_add_u32 v17, v18, 9, v17
L_qpoll:
    buffer_load_dwordx4 v[24:27], v17, s[68:71], s93 offen sc1
    s_waitcnt vmcnt(0)
    v_xor_b32 v24, s78, v24
    v_xor_b32 v25, s78, v25
    v_xor_b32 v26, s78, v26
    v_xor_b32 v27, s78, v27
    v_or3_b32 v14, v24, v25, v26
    v_or_b32 v14, v14, v27
    v_and_b32 v14, 1023, v14
    v_cmp_ne_u32 vcc, 0, v14
    s_cbranch_vccnz L_qfail
    buffer_load_dwordx4 v[24:27], v9, s[68:71], s93 offen offset:0 sc1
    buffer_load_dwordx4 v[28:31], v9, s[68:71], s93 offen offset:2048 sc1
    buffer_load_dwordx4 v[32:35], v12, s[68:71], s93 offen offset:0 sc1
    buffer_load_dwordx4 v[36:39], v12, s[68:71], s93 offen offset:2048 sc1
    buffer_load_dwordx4 v[40:43], v9, s[68:71], s94 offen offset:0 sc1
    buffer_load_dwordx4 v[44:47], v9, s[68:71], s94 offen offset:2048 sc1
    buffer_load_dwordx4 v[48:51], v12, s[68:71], s94 offen offset:0 sc1
    buffer_load_dwordx4 v[52:55], v12, s[68:71], s94 offen offset:2048 sc1
    buffer_load_dwordx4 v[84:87], v9, s[68:71], s93 offen offset:1024 sc1
    buffer_load_dwordx4 v[88:91], v9, s[68:71], s93 offen offset:3072 sc1
    buffer_load_dwordx4 v[92:95], v12, s[68:71], s93 offen offset:1024 sc1
    buffer_load_dwordx4 v[96:99], v12, s[68:71], s93 offen offset:3072 sc1
    buffer_load_dwordx4 v[100:103], v9, s[68:71], s94 offen offset:1024 sc1
    buffer_load_dwordx4 v[104:107], v9, s[68:71], s94 offen offset:3072 sc1
    buffer_load_dwordx4 v[108:111], v12, s[68:71], s94 offen offset:1024 sc1
    buffer_load_dwordx4 v[112:115], v12, s[68:71], s94 offen offset:3072 sc1
    s_waitcnt vmcnt(0)
    v_xor_b32 v24, s78, v24
    v_xor_b32 v25, s78, v25
    v_xor_b32 v26, s78, v26
    v_xor_b32 v27, s78, v27
    v_xor_b32 v28, s78, v28
    v_xor_b32 v29, s78, v29
    v_xor_b32 v30, s78, v30
    v_xor_b32 v31, s78, v31
    v_xor_b32 v32, s78, v32
    v_xor_b32 v33, s78, v33
    v_xor_b32 v34, s78, v34
    v_xor_b32 v35, s78, v35
    v_xor_b32 v36, s78, v36
    v_xor_b32 v37, s78, v37
    v_xor_b32 v38, s78, v38
    v_xor_b32 v39, s78, v39
    v_xor_b32 v40, s78, v40
    v_xor_b32 v41, s78, v41
    v_xor_b32 v42, s78, v42
    v_xor_b32 v43, s78, v43
    v_xor_b32 v44, s78, v44
    v_xor_b32 v45, s78, v45
    v_xor_b32 v46, s78, v46
    v_xor_b32 v47, s78, v47
    v_xor_b32 v48, s78, v48
    v_xor_b32 v49, s78, v49
    v_xor_b32 v50, s78, v50
    v_xor_b32 v51, s78, v51
    v_xor_b32 v52, s78, v52
    v_xor_b32 v53, s78, v53
    v_xor_b32 v54, s78, v54
    v_xor_b32 v55, s78, v55
    v_xor_b32 v84, s78, v84
    v_xor_b32 v85, s78, v85
    v_xor_b32 v86, s78, v86
    v_xor_b32 v87, s78, v87
    v_xor_b32 v88, s78, v88
    v_xor_b32 v89, s78, v89
    v_xor_b32 v90, s78, v90
    v_xor_b32 v91, s78, v91
    v_xor_b32 v92, s78, v92
    v_xor_b32 v93, s78, v93
    v_xor_b32 v94, s78, v94
    v_xor_b32 v95, s78, v95
    v_xor_b32 v96, s78, v96
    v_xor_b32 v97, s78, v97
    v_xor_b32 v98, s78, v98
    v_xor_b32 v99, s78, v99
    v_xor_b32 v100, s78, v100
    v_xor_b32 v101, s78, v101
    v_xor_b32 v102, s78, v102
    v_xor_b32 v103, s78, v103
    v_xor_b32 v104, s78, v104
    v_xor_b32 v105, s78, v105
    v_xor_b32 v106, s78, v106
    v_xor_b32 v107, s78, v107
    v_xor_b32 v108, s78, v108
    v_xor_b32 v109, s78, v109
    v_xor_b32 v110, s78, v110
    v_xor_b32 v111, s78, v111
    v_xor_b32 v112, s78, v112
    v_xor_b32 v113, s78, v113
    v_xor_b32 v114, s78, v114
    v_xor_b32 v115, s78, v115
    v_or3_b32 v14, v24, v25, v26
    v_or3_b32 v15, v27, v28, v29
    v_or3_b32 v14, v14, v30, v31
    v_or3_b32 v15, v15, v32, v33
    v_or3_b32 v14, v14, v34, v35
    v_or3_b32 v15, v15, v36, v37
    v_or3_b32 v14, v14, v38, v39
    v_or3_b32 v15, v15, v40, v41
    v_or3_b32 v14, v14, v42, v43
    v_or3_b32 v15, v15, v44, v45
    v_or3_b32 v14, v14, v46, v47
    v_or3_b32 v15, v15, v48, v49
    v_or3_b32 v14, v14, v50, v51
    v_or3_b32 v15, v15, v52, v53
    v_or3_b32 v14, v14, v54, v55
    v_or3_b32 v15, v15, v84, v85
    v_or3_b32 v14, v14, v86, v87
    v_or3_b32 v15, v15, v88, v89
    v_or3_b32 v14, v14, v90, v91
    v_or3_b32 v15, v15, v92, v93
    v_or3_b32 v14, v14, v94, v95
    v_or3_b32 v15, v15, v96, v97
    v_or3_b32 v14, v14, v98, v99
    v_or3_b32 v15, v15, v100, v101
    v_or3_b32 v14, v14, v102, v103
    v_or3_b32 v15, v15, v104, v105
    v_or3_b32 v14, v14, v106, v107
    v_or3_b32 v15, v15, v108, v109
    v_or3_b32 v14, v14, v110, v111
    v_or3_b32 v15, v15, v112, v113
    v_or3_b32 v14, v14, v114, v115
    v_or_b32 v14, v14, v15
    v_and_b32 v14, 1023, v14
    v_cmp_ne_u32 vcc, 0, v14
    s_cbranch_vccz L_qok0
L_qfail:
    s_sleep 4
    s_sub_u32 s76, s76, 1
    s_cbranch_scc0 L_qnosw
    buffer_store_dwordx4 v[76:79], v16, s[68:71], s99 offen sc1
    buffer_store_dwordx4 v[80:83], v16, s[68:71], s99 offen offset:512 sc1
L_qnosw:
    s_cmp_lt_i32 s76, 0
    s_cselect_b32 s82, 1048576, 0
    s_xor_b32 s93, s93, s82
    s_xor_b32 s94, s94, s82
    s_sub_u32 s92, s92, 1
    s_cbranch_scc0 L_qpoll
    s_endpgm
L_qok0:
    v_xor_b32 v56, s88, v25
    v_xor_b32 v57, s88, v29
    v_xor_b32 v58, s88, v33
    v_xor_b32 v59, s88, v37
    v_xor_b32 v60, s88, v41
    v_xor_b32 v61, s88, v45
    v_xor_b32 v62, s88, v49
    v_xor_b32 v63, s88, v53
    v_or3_b32 v14, v56, v57, v58
    v_or3_b32 v15, v59, v60, v61
    v_or3_b32 v14, v14, v62, v63
    v_or_b32 v14, v14, v15
    s_nop 0
    v_readlane_b32 s86, v14, 60
    s_cmp_lg_u32 s86, 0
    s_cselect_b32 s86, 2, 1
    s_cbranch_scc0 L_qok
    s_cmp_lt_i32 s76, 0
    s_cbranch_scc1 L_qok
    buffer_store_dwordx4 v[76:79], v16, s[68:71], s99 offen sc1
    buffer_store_dwordx4 v[80:83], v16, s[68:71], s99 offen offset:512 sc1
L_qok:
    v_lshlrev_b32 v10, 3, v1
    v_add_f32 v24, v24, v28
    v_add_f32 v25, v25, v29
    v_add_f32 v26, v26, v30
    v_add_f32 v27, v27, v31
    v_add_f32 v32, v32, v36
    v_add_f32 v33, v33, v37
    v_add_f32 v34, v34, v38
    v_add_f32 v35, v35, v39
    v_add_f32 v40, v40, v44
    v_add_f32 v41, v41, v45
    v_add_f32 v42, v42, v46
    v_add_f32 v43, v43, v47
    v_add_f32 v48, v48, v52
    v_add_f32 v49, v49, v53
    v_add_f32 v50, v50, v54
    v_add_f32 v51, v51, v55
    v_add_f32 v24, v24, v32
    v_add_f32 v25, v25, v33
    v_add_f32 v26, v26, v34
    v_add_f32 v27, v27, v35
    v_add_f32 v40, v40, v48
    v_add_f32 v41, v41, v49
    v_add_f32 v42, v42, v50
    v_add_f32 v43, v43, v51
    v_add_f32 v24, v24, v40
    v_add_f32 v25, v25, v41
    v_add_f32 v26, v26, v42
    v_add_f32 v27, v27, v43
    v_cvt_pk_bf16_f32 v28, v24, v25
    v_cvt_pk_bf16_f32 v29, v26, v27
    ds_write_b64 v10, v[28:29] offset:27136
    v_add_f32 v84, v84, v88
    v_add_f32 v85, v85, v89
    v_add_f32 v86, v86, v90
    v_add_f32 v87, v87, v91
    v_add_f32 v92, v92, v96
    v_add_f32 v93, v93, v97
    v_add_f32 v94, v94, v98
    v_add_f32 v95, v95, v99
    v_add_f32 v100, v100, v104
    v_add_f32 v101, v101, v105
    v_add_f32 v102, v102, v106
    v_add_f32 v103, v103, v107
    v_add_f32 v108, v108, v112
    v_add_f32 v109, v109, v113
    v_add_f32 v110, v110, v114
    v_add_f32 v111, v111, v115
    v_add_f32 v84, v84, v92
    v_add_f32 v85, v85, v93
    v_add_f32 v86, v86, v94
    v_add_f32 v87, v87, v95
    v_add_f32 v100, v100, v108
    v_add_f32 v101, v101, v109
    v_add_f32 v102, v102, v110
    v_add_f32 v103, v103, v111
    v_add_f32 v84, v84, v100
    v_add_f32 v85, v85, v101
    v_add_f32 v86, v86, v102
    v_add_f32 v87, v87, v103
    v_cvt_pk_bf16_f32 v88, v84, v85
    v_cvt_pk_bf16_f32 v89, v86, v87
    ds_write_b64 v10, v[88:89] offset:27648
    v_mov_b32 v10, s86
    ds_write_b32 v73, v10 offset:28800
    v_permlane16_swap_b32 v24, v84
    v_permlane16_swap_b32 v25, v85
    v_permlane16_swap_b32 v26, v86
    v_permlane16_swap_b32 v27, v87
    v_mov_b32_dpp v32, v84 row_newbcast:12 row_mask:0xf bank_mask:0xf
    v_cvt_pk_bf16_f32 v32, v32, v32
    v_and_b32 v32, 0xffff0000, v32
    v_mul_f32 v32, 3216550459, v32
    v_exp_f32 v32, v32
    s_nop 0
    v_add_f32 v32, 1.0, v32
    v_rcp_f32 v32, v32
    s_nop 0
    v_cvt_pk_bf16_f32 v32, v32, v32
    v_and_b32 v32, 0xffff0000, v32
    v_sub_f32 v33, 1.0, v32
    v_cvt_pk_bf16_f32 v33, v33, v33
    v_and_b32 v33, 0xffff0000, v33
    s_mov_b32 s83, 3216550459
    v_cvt_pk_bf16_f32 v84, v84, v85
    v_and_b32 v85, 0xffff0000, v84
    v_lshlrev_b32 v84, 16, v84
    v_and_b32 v35, 0xffff0000, v74
    v_lshlrev_b32 v34, 16, v74
    v_add_f32 v84, v84, v34
    v_add_f32 v85, v85, v35
    v_cvt_pk_bf16_f32 v84, v84, v85
    v_and_b32 v85, 0xffff0000, v84
    v_lshlrev_b32 v84, 16, v84
    v_cvt_pk_bf16_f32 v86, v86, v87
    v_and_b32 v87, 0xffff0000, v86
    v_lshlrev_b32 v86, 16, v86
    v_and_b32 v35, 0xffff0000, v75
    v_lshlrev_b32 v34, 16, v75
    v_add_f32 v86, v86, v34
    v_add_f32 v87, v87, v35
    v_cvt_pk_bf16_f32 v86, v86, v87
    v_and_b32 v87, 0xffff0000, v86
    v_lshlrev_b32 v86, 16, v86
    v_mul_f32 v36, s83, abs(v84)
    v_exp_f32 v36, v36
    v_cmp_lt_f32 vcc, 0, v84
    v_mul_f32 v37, v36, v36
    s_nop 0
    v_cndmask_b32 v38, v37, 1.0, vcc
    v_cndmask_b32 v39, 1.0, v37, vcc
    v_fma_f32 v38, v36, 2.0, v38
    v_fma_f32 v39, v39, 2.0, v38
    v_rcp_f32 v39, v39
    v_mul_f32 v38, v38, v84
    v_mul_f32 v38, v38, v39
    v_cvt_pk_bf16_f32 v38, v38, v38
    v_and_b32 v38, 0xffff0000, v38
    v_mul_f32 v38, v38, v33
    v_cvt_pk_bf16_f32 v40, v38, v38
    v_mul_f32 v36, s83, abs(v85)
    v_exp_f32 v36, v36
    v_cmp_lt_f32 vcc, 0, v85
    v_mul_f32 v37, v36, v36
    s_nop 0
    v_cndmask_b32 v38, v37, 1.0, vcc
    v_cndmask_b32 v39, 1.0, v37, vcc
    v_fma_f32 v38, v36, 2.0, v38
    v_fma_f32 v39, v39, 2.0, v38
    v_rcp_f32 v39, v39
    v_mul_f32 v38, v38, v85
    v_mul_f32 v38, v38, v39
    v_cvt_pk_bf16_f32 v38, v38, v38
    v_and_b32 v38, 0xffff0000, v38
    v_mul_f32 v38, v38, v33
    v_cvt_pk_bf16_f32 v41, v38, v38
    v_mul_f32 v36, s83, abs(v86)
    v_exp_f32 v36, v36
    v_cmp_lt_f32 vcc, 0, v86
    v_mul_f32 v37, v36, v36
    s_nop 0
    v_cndmask_b32 v38, v37, 1.0, vcc
    v_cndmask_b32 v39, 1.0, v37, vcc
    v_fma_f32 v38, v36, 2.0, v38
    v_fma_f32 v39, v39, 2.0, v38
    v_rcp_f32 v39, v39
    v_mul_f32 v38, v38, v86
    v_mul_f32 v38, v38, v39
    v_cvt_pk_bf16_f32 v38, v38, v38
    v_and_b32 v38, 0xffff0000, v38
    v_mul_f32 v38, v38, v33
    v_cvt_pk_bf16_f32 v42, v38, v38
    v_mul_f32 v36, s83, abs(v87)
    v_exp_f32 v36, v36
    v_cmp_lt_f32 vcc, 0, v87
    v_mul_f32 v37, v36, v36
    s_nop 0
    v_cndmask_b32 v38, v37, 1.0, vcc
    v_cndmask_b32 v39, 1.0, v37, vcc
    v_fma_f32 v38, v36, 2.0, v38
    v_fma_f32 v39, v39, 2.0, v38
    v_rcp_f32 v39, v39
    v_mul_f32 v38, v38, v87
    v_mul_f32 v38, v38, v39
    v_cvt_pk_bf16_f32 v38, v38, v38
    v_and_b32 v38, 0xffff0000, v38
    v_mul_f32 v38, v38, v33
    v_cvt_pk_bf16_f32 v43, v38, v38
    v_and_b32 v10, 31, v1
    v_lshlrev_b32 v11, 2, v10
    v_lshlrev_b32 v10, 4, v10
    s_mov_b32 exec_lo, 0
    ds_write_b32 v11, v32 offset:28672
    ds_write_b128 v10, v[40:43] offset:28160
    s_mov_b64 exec, 1
    v_mov_b32 v10, 1
    ds_add_u32 v73, v10 offset:28808
    s_mov_b64 exec, -1
    s_waitcnt lgkmcnt(0)
    s_and_b32 s82, s2, 7
    s_mul_i32 s82, s82, 4352
    s_add_u32 s82, s82, 1839104
    s_lshr_b32 s83, s2, 3
    s_lshl_b32 s83, s83, 2
    s_add_u32 s83, s83, s82
    s_and_b32 s84, s79, 0x3fffff
    s_mov_b32 s85, 0
    v_lshlrev_b32 v11, 2, v1
    v_mul_u32_u24 v13, 256, v1
    s_cmp_ge_u32 s2, 248
    s_cselect_b32 s60, 208, -1
    s_mov_b32 s61, 1900544
    s_and_b32 s59, s2, 7
    s_mul_i32 s58, s59, 256
    s_add_u32 s43, s82, 128
    s_mov_b32 s57, 0
    s_mov_b32 exec_hi, 0
L_c:
    ds_read_b32 v10, v73 offset:28804
    s_waitcnt lgkmcnt(0)
    v_subrev_u32 v10, s85, v10
    v_lshl_or_b32 v12, v10, 22, s84
    s_mov_b32 exec_lo, 1
    buffer_store_dword v12, off, s[68:71], s83
    s_mov_b32 exec_lo, -1
    s_mov_b32 exec_hi, 1
    buffer_load_dword v9, v11, s[68:71], s82 offen sc1
    s_mov_b32 exec_hi, 0
    v_readfirstlane_b32 s86, v10
    s_cmp_lt_u32 s86, s60
    s_cbranch_scc1 L_g1
    s_memrealtime s[62:63]
    s_mov_b32 exec_lo, 0xff
    buffer_load_dword v14, v13, s[68:71], s61 offen sc1
    s_mov_b32 exec_lo, -1
L_g1:
    s_waitcnt vmcnt(0)
    v_readlane_b32 s44, v9, 32
    s_and_b32 s45, s44, 0x3fffff
    s_ashr_i32 s44, s44, 22
    s_cmp_eq_u32 s45, s84
    s_cselect_b32 s44, s44, 0
    v_and_b32 v12, 0x3fffff, v9
    v_lshrrev_b32 v9, 22, v9
    v_add_u32 v9, 7, v9
    v_cmp_eq_u32 vcc, s84, v12
    s_nop 1
    v_cndmask_b32 v9, v10, v9, vcc
    s_nop 1
    v_add_u32_dpp v9, v9, v9 quad_perm:[1,0,3,2] row_mask:0xf bank_mask:0xf
    s_nop 1
    v_add_u32_dpp v9, v9, v9 quad_perm:[2,3,0,1] row_mask:0xf bank_mask:0xf
    s_nop 1
    v_add_u32_dpp v9, v9, v9 row_half_mirror row_mask:0xf bank_mask:0xf
    s_nop 1
    v_add_u32_dpp v9, v9, v9 row_mirror row_mask:0xf bank_mask:0xf
    s_nop 0
    v_readlane_b32 s87, v9, 0
    v_readlane_b32 s88, v9, 16
    s_add_u32 s87, s87, s88
    s_lshr_b32 s87, s87, 5
    s_cmp_lt_u32 s86, s60
    s_cbranch_scc1 L_g2
    s_waitcnt lgkmcnt(0)
    s_mul_i32 s64, s62, 76
    s_lshr_b32 s64, s64, 8
    s_sub_u32 s64, s87, s64
    s_lshl_b32 s64, s64, 22
    s_or_b32 s64, s64, s84
    s_add_u32 s61, s61, 2048
    s_add_u32 s45, s61, s58
    v_mov_b32 v12, s64
    s_mov_b32 exec_lo, 1
    buffer_store_dword v12, off, s[68:71], s45 sc1
    s_mov_b32 exec_lo, 0xff
    s_add_u32 s60, s60, 64
    s_cmp_gt_u32 s60, 660
    s_cselect_b32 s60, -1, s60
    v_subrev_u32 v14, s57, v14
    v_and_b32 v12, 0x3fffff, v14
    v_ashrrev_i32 v14, 22, v14
    v_cmp_eq_u32 vcc, 0, v12
    v_mov_b32 v15, -64
    s_nop 0
    v_cndmask_b32 v14, v15, v14, vcc
    s_nop 1
    v_add_u32_dpp v14, v14, v14 quad_perm:[1,0,3,2] row_mask:0xf bank_mask:0xf
    s_nop 1
    v_add_u32_dpp v14, v14, v14 quad_perm:[2,3,0,1] row_mask:0xf bank_mask:0xf
    s_nop 1
    v_add_u32_dpp v14, v14, v14 row_half_mirror row_mask:0xf bank_mask:0xf
    s_nop 0
    v_readfirstlane_b32 s46, v14
    s_ashr_i32 s46, s46, 5
    s_min_i32 s46, s46, 24
    s_max_i32 s46, s46, -24
    s_cmp_eq_u32 s57, 0
    s_cselect_b32 s46, 0, s46
    s_mov_b32 s57, s64
    s_lshl_b32 s46, s46, 22
    s_or_b32 s46, s46, s84
    v_mov_b32 v12, s46
    s_mov_b32 exec_lo, 1
    buffer_store_dword v12, off, s[68:71], s43
    s_mov_b32 exec_lo, -1
L_g2:
    s_sub_i32 s87, s87, s86
    s_add_i32 s87, s87, s44
    s_sub_i32 s88, s87, s85
    s_mov_b32 s85, s87
    v_mov_b32 v9, s88
    s_mov_b32 exec_lo, 1
    ds_add_u32 v73, v9 offset:28804
    s_mov_b32 exec_lo, -1
    s_cmp_ge_u32 s86, 712
    s_cbranch_scc1 L_cd
    s_sub_u32 s92, s92, 1
    s_cbranch_scc0 L_c
    s_endpgm
L_cd:
    s_mov_b64 exec, -1
    s_cmp_ge_u32 s2, 160
    s_cbranch_scc1 L_end
    s_and_b32 s82, s2, 7
    s_lshr_b32 s83, s2, 3
    s_mul_i32 s84, s82, 20480
    s_lshl_b32 s81, s83, 5
    s_add_u32 s84, s84, s81
    s_add_u32 s98, s84, 1572864
    s_mov_b32 s72, s24
    s_mov_b32 s73, s25
    s_mov_b32 s74, 2560
    s_mov_b32 s75, 0x20000
    v_lshrrev_b32 v8, 1, v1
    v_mul_u32_u24 v8, 640, v8
    v_and_b32 v10, 1, v1
    v_lshl_add_u32 v8, v10, 4, v8
    s_cmp_ge_u32 s83, 10
    s_cselect_b32 s84, 1120, 0
    s_lshl_b32 s81, s83, 4
    s_add_u32 s84, s84, s81
    s_mul_i32 s81, s82, 160
    s_add_u32 s99, s84, s81
    v_lshlrev_b32 v9, 3, v10
    v_lshrrev_b32 v10, 4, v1
    v_lshl_add_u32 v9, v10, 1, v9
    v_mov_b32 v11, s79
    s_mov_b32 s82, 1835008
    s_waitcnt lgkmcnt(0)
    s_barrier
    s_barrier
    s_barrier
L_poll2:
    buffer_load_dwordx4 v[28:31], v8, s[68:71], s98 offen sc1
    s_waitcnt vmcnt(0)
    v_xor_b32 v28, s78, v28
    v_xor_b32 v29, s78, v29
    v_xor_b32 v30, s78, v30
    v_xor_b32 v31, s78, v31
    v_or3_b32 v14, v28, v29, v30
    v_or_b32 v14, v14, v31
    v_and_b32 v14, 1023, v14
    v_cmp_ne_u32 vcc, 0, v14
    s_cbranch_vccz L_poll2d
    s_mov_b64 exec, vcc
    s_sleep 1
    s_sub_u32 s92, s92, 1
    s_cbranch_scc0 L_poll2
    s_endpgm
L_poll2d:
    s_mov_b64 exec, -1
    v_permlane16_swap_b32 v28, v29
    v_permlane16_swap_b32 v30, v31
    v_add_f32 v28, v28, v29
    v_add_f32 v30, v30, v31
    s_nop 1
    v_permlane32_swap_b32 v28, v30
    v_add_f32 v28, v28, v30
    s_nop 1
    v_add_f32_dpp v28, v28, v28 quad_perm:[2,3,0,1] row_mask:0xf bank_mask:0xf
    s_nop 1
    v_add_f32_dpp v28, v28, v28 row_ror:4 row_mask:0xf bank_mask:0xf
    s_nop 1
    v_add_f32_dpp v28, v28, v28 row_ror:8 row_mask:0xf bank_mask:0xf
    s_mov_b32 exec_lo, 0x00030003
    s_mov_b32 exec_hi, 0x00030003
    v_cvt_pk_bf16_f32 v28, v28, v28
    buffer_store_short v28, v9, s[72:75], s99 offen
    s_cmp_lg_u32 s2, 0
    s_cbranch_scc1 L_hend
    s_mov_b64 exec, 1
    buffer_store_dword v11, off, s[68:71], s82
L_hend:
    s_endpgm
L_codeend:
.section .rodata,"a"
.p2align 6
.amdhsa_kernel gated_mix__gqa_block_cached__dense_activation_mish__decode_kernel
  .amdhsa_next_free_vgpr 168
  .amdhsa_next_free_sgpr 102
  .amdhsa_accum_offset 168
  .amdhsa_group_segment_fixed_size 0
  .amdhsa_kernarg_size 104
  .amdhsa_user_sgpr_count 2
  .amdhsa_user_sgpr_kernarg_segment_ptr 1
  .amdhsa_system_sgpr_workgroup_id_x 1
  .amdhsa_float_denorm_mode_32 3
.end_amdhsa_kernel
```
